```python
import torch

def _softmax(x, axis=-1):
    return torch.softmax(x, dim=axis)
def _gelu(x):
    return torch.nn.functional.gelu(x, approximate="tanh")
def _silu(x):
    return torch.nn.functional.silu(x)
def _sigmoid(x):
    return torch.sigmoid(x)
def _layernorm(x, axis=-1, eps=1e-5):
    m = x.mean(dim=axis, keepdim=True)
    v = x.var(dim=axis, keepdim=True, unbiased=False)
    return (x - m) / torch.sqrt(v + eps)
def _scatter_add(tgt, idx, src, axis=0):
    return tgt.clone().index_add_(axis, idx, src)
def _segment_sum(src, seg, n):
    out = torch.zeros((n,) + src.shape[1:], dtype=src.dtype)
    return out.index_add_(0, seg, src)
def _pad(x, pw):
    flat = tuple(v for pair in reversed(pw) for v in pair)
    return torch.nn.functional.pad(x, flat)

kernel_name = 'parallel_sum__spectral_fnet__dense_activation_relu__prompt'

def setup_inputs():

    _w = (lambda a: (lambda t: t.to(torch.bfloat16) if t.is_floating_point() else t)(torch.as_tensor(a)))
    def _A_setup():
        B, S, D = 1, 2048, 576
        ns = torch.arange(S)[:, None] * torch.arange(S)[None, :]
        nd = torch.arange(D)[:, None] * torch.arange(D)[None, :]
        Ws_re = torch.cos(-2.0 * torch.pi * ns / S).to(float)
        Ws_im = torch.sin(-2.0 * torch.pi * ns / S).to(float)
        Wd_re = torch.cos(-2.0 * torch.pi * nd / D).to(float)
        Wd_im = torch.sin(-2.0 * torch.pi * nd / D).to(float)
        return {
            "x": _w((lambda *s: torch.randn(*s, dtype=torch.bfloat16) * 0.05)(B, S, D)),
            "dft_seq_re": _w(Ws_re),
            "dft_seq_im": _w(Ws_im),
            "dft_hid_re": _w(Wd_re),
            "dft_hid_im": _w(Wd_im),
        }
    _A_in = _A_setup()

    def _B_setup():
        B, S, D, Dff = 1, 2048, 576, 4608
        return {
            "x": _w((lambda *s: torch.randn(*s, dtype=torch.bfloat16) * 0.05)(B, S, D)),
            "w1": _w((lambda *s: torch.randn(*s, dtype=torch.bfloat16) * 0.4)(D, Dff)),
            "w2": _w((lambda *s: torch.randn(*s, dtype=torch.bfloat16) * 0.4)(Dff, D)),
        }
    _B_in = _B_setup()

    return {
        "A_x": _A_in["x"],
        "A_dft_seq_re": _A_in["dft_seq_re"],
        "A_dft_seq_im": _A_in["dft_seq_im"],
        "A_dft_hid_re": _A_in["dft_hid_re"],
        "A_dft_hid_im": _A_in["dft_hid_im"],
        "B_x": _B_in["x"],
        "B_w1": _B_in["w1"],
        "B_w2": _B_in["w2"],
    }

def reference(A_x, A_dft_seq_re, A_dft_seq_im, A_dft_hid_re, A_dft_hid_im, B_x, B_w1, B_w2):
    def _A_ref(x, dft_seq_re, dft_seq_im, dft_hid_re, dft_hid_im):
        a = torch.einsum("bsd,ed->bse", x, dft_hid_re)
        b = torch.einsum("bsd,ed->bse", x, dft_hid_im)
        y = torch.einsum("ts,bse->bte", dft_seq_re, a) - torch.einsum("ts,bse->bte", dft_seq_im, b)
        return y

    def _B_ref(x, w1, w2):
        h = torch.einsum("bsd,df->bsf", x, w1)
        zero = torch.zeros_like(h)
        h = torch.maximum(h, zero)
        return torch.einsum("bsf,fd->bsd", h, w2)

    x = A_x
    xn = _layernorm(x, axis=-1)
    return x + _A_ref(xn, A_dft_seq_re, A_dft_seq_im, A_dft_hid_re, A_dft_hid_im) + _B_ref(xn, B_w1, B_w2)
```

```asm
; @launch grid=(240,1,1) block=(768,1,1) lds=163840
.amdgcn_target "amdgcn-amd-amdhsa--gfx950"
.text
.globl parallel_sum__spectral_fnet__dense_activation_relu__prompt_kernel
.p2align 8
.type parallel_sum__spectral_fnet__dense_activation_relu__prompt_kernel,@function
parallel_sum__spectral_fnet__dense_activation_relu__prompt_kernel:
    s_cmp_ge_u32 s2, 240
    s_cbranch_scc1 K_done
    s_load_dwordx8 s[4:11], s[0:1], 0
    s_load_dwordx2 s[12:13], s[0:1], 32
    s_load_dwordx4 s[16:19], s[0:1], 48
    s_load_dwordx4 s[20:23], s[0:1], 64
    s_load_dwordx2 s[24:25], s[0:1], 80
    v_lshrrev_b32 v1, 6, v0
    s_and_b32 s33, s2, 7
    s_mul_i32 s33, s33, 30
    s_lshr_b32 s34, s2, 3
    v_readfirstlane_b32 s3, v1
    s_add_u32 s33, s33, s34
    s_lshr_b32 s34, s33, 3
    s_and_b32 s35, s33, 7
    s_cmp_ge_u32 s33, 120
    s_cselect_b32 s40, 120, 0
    s_cselect_b32 s41, 8, 0
    s_sub_u32 s40, s33, s40
    s_lshr_b32 s65, s40, 3
    s_and_b32 s64, s40, 7
    s_add_u32 s64, s64, s41
    s_mul_i32 s26, s33, 1366
    s_lshr_b32 s26, s26, 16
    s_mul_i32 s40, s26, 48
    s_sub_u32 s27, s33, s40
    s_mul_i32 s32, s27, 21846
    s_lshr_b32 s32, s32, 16
    s_mul_i32 s40, s32, 3
    s_sub_u32 s39, s27, s40
    s_cmp_eq_u32 s26, 4
    s_cselect_b32 s66, 12, 13
    s_cmp_eq_u32 s26, 3
    s_cselect_b32 s67, 28, 27
    s_add_u32 s36, s67, 18
    s_sub_u32 s89, s67, 9
    s_waitcnt lgkmcnt(0)
    s_mov_b32 s28, s22
    s_and_b32 s29, s23, 0xffff
    s_mov_b32 s30, 256
    s_mov_b32 s31, 0x00020000
    s_add_u32 s92, s24, 66060288
    s_addc_u32 s93, s25, 0
    s_and_b32 s93, s93, 0xffff
    s_mov_b32 s94, 24576
    s_mov_b32 s95, 0x00020000
    s_or_b32 s40, s2, s3
    s_cmp_lg_u32 s40, 0
    s_cbranch_scc1 K_nopub
    s_memrealtime s[40:41]
    s_waitcnt lgkmcnt(0)
    s_or_b32 s40, s40, 1
    v_mov_b32 v60, s40
    v_mov_b32 v61, s41
    v_mov_b32 v63, 0
    s_mov_b64 exec, 1
    buffer_store_dwordx2 v[60:61], v63, s[28:31], 0 offen sc1
    s_mov_b64 exec, -1
K_nopub:
    s_cmp_ge_u32 s3, 8
    s_cbranch_scc1 K_loader
    s_and_b32 s40, s3, 3
    s_lshr_b32 s37, s40, 1
    s_and_b32 s38, s40, 1
    s_cmp_ge_u32 s3, 4
    s_cbranch_scc1 K_g1
    s_cmp_ge_u32 s3, 3
    s_cbranch_scc1 K_lnskip
    v_lshrrev_b32 v1, 4, v0
    v_mul_u32_u24 v2, 30, v1
    v_add_u32 v2, s34, v2
    s_lshl_b32 s40, s35, 8
    v_add_u32 v3, s40, v2
    v_mul_u32_u24 v3, 1152, v3
    v_and_b32 v4, 15, v0
    v_lshl_add_u32 v3, v4, 3, v3
    v_mov_b32 v4, 0x7f000000
    v_cmp_gt_u32 vcc, 256, v2
    s_nop 1
    v_cndmask_b32 v1, v4, v3, vcc
    s_mov_b32 s68, s4
    s_and_b32 s69, s5, 0xffff
    s_mov_b32 s70, 2359296
    s_mov_b32 s71, 0x00020000
    s_add_u32 s72, s24, 0
    s_addc_u32 s73, s25, 0
    s_and_b32 s73, s73, 0xffff
    s_mov_b32 s74, 2359296
    s_mov_b32 s75, 0x00020000
    buffer_load_dwordx2 v[4:5], v1, s[68:71], 0 offen offset:0
    buffer_load_dwordx2 v[6:7], v1, s[68:71], 0 offen offset:128
    buffer_load_dwordx2 v[8:9], v1, s[68:71], 0 offen offset:256
    buffer_load_dwordx2 v[10:11], v1, s[68:71], 0 offen offset:384
    buffer_load_dwordx2 v[12:13], v1, s[68:71], 0 offen offset:512
    buffer_load_dwordx2 v[14:15], v1, s[68:71], 0 offen offset:640
    buffer_load_dwordx2 v[16:17], v1, s[68:71], 0 offen offset:768
    buffer_load_dwordx2 v[18:19], v1, s[68:71], 0 offen offset:896
    buffer_load_dwordx2 v[20:21], v1, s[68:71], 0 offen offset:1024
    s_waitcnt vmcnt(8)
    v_lshlrev_b32 v24, 16, v4
    v_and_b32 v25, 0xffff0000, v4
    v_lshlrev_b32 v26, 16, v5
    v_and_b32 v27, 0xffff0000, v5
    s_waitcnt vmcnt(7)
    v_lshlrev_b32 v28, 16, v6
    v_and_b32 v29, 0xffff0000, v6
    v_lshlrev_b32 v30, 16, v7
    v_and_b32 v31, 0xffff0000, v7
    s_waitcnt vmcnt(6)
    v_lshlrev_b32 v32, 16, v8
    v_and_b32 v33, 0xffff0000, v8
    v_lshlrev_b32 v34, 16, v9
    v_and_b32 v35, 0xffff0000, v9
    s_waitcnt vmcnt(5)
    v_lshlrev_b32 v36, 16, v10
    v_and_b32 v37, 0xffff0000, v10
    v_lshlrev_b32 v38, 16, v11
    v_and_b32 v39, 0xffff0000, v11
    s_waitcnt vmcnt(4)
    v_lshlrev_b32 v40, 16, v12
    v_and_b32 v41, 0xffff0000, v12
    v_lshlrev_b32 v42, 16, v13
    v_and_b32 v43, 0xffff0000, v13
    s_waitcnt vmcnt(3)
    v_lshlrev_b32 v44, 16, v14
    v_and_b32 v45, 0xffff0000, v14
    v_lshlrev_b32 v46, 16, v15
    v_and_b32 v47, 0xffff0000, v15
    s_waitcnt vmcnt(2)
    v_lshlrev_b32 v48, 16, v16
    v_and_b32 v49, 0xffff0000, v16
    v_lshlrev_b32 v50, 16, v17
    v_and_b32 v51, 0xffff0000, v17
    s_waitcnt vmcnt(1)
    v_lshlrev_b32 v52, 16, v18
    v_and_b32 v53, 0xffff0000, v18
    v_lshlrev_b32 v54, 16, v19
    v_and_b32 v55, 0xffff0000, v19
    s_waitcnt vmcnt(0)
    v_lshlrev_b32 v56, 16, v20
    v_and_b32 v57, 0xffff0000, v20
    v_lshlrev_b32 v58, 16, v21
    v_and_b32 v59, 0xffff0000, v21
    v_add_f32 v60, v24, v25
    v_add_f32 v61, v26, v27
    v_add_f32 v60, v60, v28
    v_add_f32 v61, v61, v29
    v_add_f32 v60, v60, v30
    v_add_f32 v61, v61, v31
    v_add_f32 v60, v60, v32
    v_add_f32 v61, v61, v33
    v_add_f32 v60, v60, v34
    v_add_f32 v61, v61, v35
    v_add_f32 v60, v60, v36
    v_add_f32 v61, v61, v37
    v_add_f32 v60, v60, v38
    v_add_f32 v61, v61, v39
    v_add_f32 v60, v60, v40
    v_add_f32 v61, v61, v41
    v_add_f32 v60, v60, v42
    v_add_f32 v61, v61, v43
    v_add_f32 v60, v60, v44
    v_add_f32 v61, v61, v45
    v_add_f32 v60, v60, v46
    v_add_f32 v61, v61, v47
    v_add_f32 v60, v60, v48
    v_add_f32 v61, v61, v49
    v_add_f32 v60, v60, v50
    v_add_f32 v61, v61, v51
    v_add_f32 v60, v60, v52
    v_add_f32 v61, v61, v53
    v_add_f32 v60, v60, v54
    v_add_f32 v61, v61, v55
    v_add_f32 v60, v60, v56
    v_add_f32 v61, v61, v57
    v_add_f32 v60, v60, v58
    v_add_f32 v61, v61, v59
    v_add_f32 v60, v60, v61
    s_nop 1
    v_add_f32_dpp v61, v60, v60 row_ror:8 row_mask:0xf bank_mask:0xf
    v_mov_b32 v60, v61
    s_nop 1
    v_add_f32_dpp v61, v60, v60 row_ror:4 row_mask:0xf bank_mask:0xf
    v_mov_b32 v60, v61
    s_nop 1
    v_add_f32_dpp v61, v60, v60 row_ror:2 row_mask:0xf bank_mask:0xf
    v_mov_b32 v60, v61
    s_nop 1
    v_add_f32_dpp v61, v60, v60 row_ror:1 row_mask:0xf bank_mask:0xf
    v_mov_b32 v60, v61
    v_mul_f32 v60, 0x3ae38e39, v60
    v_sub_f32 v62, v24, v60
    v_mul_f32 v63, v62, v62
    v_sub_f32 v62, v25, v60
    v_mul_f32 v64, v62, v62
    v_sub_f32 v62, v26, v60
    v_sub_f32 v65, v27, v60
    v_fmac_f32 v63, v62, v62
    v_fmac_f32 v64, v65, v65
    v_sub_f32 v62, v28, v60
    v_sub_f32 v65, v29, v60
    v_fmac_f32 v63, v62, v62
    v_fmac_f32 v64, v65, v65
    v_sub_f32 v62, v30, v60
    v_sub_f32 v65, v31, v60
    v_fmac_f32 v63, v62, v62
    v_fmac_f32 v64, v65, v65
    v_sub_f32 v62, v32, v60
    v_sub_f32 v65, v33, v60
    v_fmac_f32 v63, v62, v62
    v_fmac_f32 v64, v65, v65
    v_sub_f32 v62, v34, v60
    v_sub_f32 v65, v35, v60
    v_fmac_f32 v63, v62, v62
    v_fmac_f32 v64, v65, v65
    v_sub_f32 v62, v36, v60
    v_sub_f32 v65, v37, v60
    v_fmac_f32 v63, v62, v62
    v_fmac_f32 v64, v65, v65
    v_sub_f32 v62, v38, v60
    v_sub_f32 v65, v39, v60
    v_fmac_f32 v63, v62, v62
    v_fmac_f32 v64, v65, v65
    v_sub_f32 v62, v40, v60
    v_sub_f32 v65, v41, v60
    v_fmac_f32 v63, v62, v62
    v_fmac_f32 v64, v65, v65
    v_sub_f32 v62, v42, v60
    v_sub_f32 v65, v43, v60
    v_fmac_f32 v63, v62, v62
    v_fmac_f32 v64, v65, v65
    v_sub_f32 v62, v44, v60
    v_sub_f32 v65, v45, v60
    v_fmac_f32 v63, v62, v62
    v_fmac_f32 v64, v65, v65
    v_sub_f32 v62, v46, v60
    v_sub_f32 v65, v47, v60
    v_fmac_f32 v63, v62, v62
    v_fmac_f32 v64, v65, v65
    v_sub_f32 v62, v48, v60
    v_sub_f32 v65, v49, v60
    v_fmac_f32 v63, v62, v62
    v_fmac_f32 v64, v65, v65
    v_sub_f32 v62, v50, v60
    v_sub_f32 v65, v51, v60
    v_fmac_f32 v63, v62, v62
    v_fmac_f32 v64, v65, v65
    v_sub_f32 v62, v52, v60
    v_sub_f32 v65, v53, v60
    v_fmac_f32 v63, v62, v62
    v_fmac_f32 v64, v65, v65
    v_sub_f32 v62, v54, v60
    v_sub_f32 v65, v55, v60
    v_fmac_f32 v63, v62, v62
    v_fmac_f32 v64, v65, v65
    v_sub_f32 v62, v56, v60
    v_sub_f32 v65, v57, v60
    v_fmac_f32 v63, v62, v62
    v_fmac_f32 v64, v65, v65
    v_sub_f32 v62, v58, v60
    v_sub_f32 v65, v59, v60
    v_fmac_f32 v63, v62, v62
    v_fmac_f32 v64, v65, v65
    v_add_f32 v63, v63, v64
    s_nop 1
    v_add_f32_dpp v61, v63, v63 row_ror:8 row_mask:0xf bank_mask:0xf
    v_mov_b32 v63, v61
    s_nop 1
    v_add_f32_dpp v61, v63, v63 row_ror:4 row_mask:0xf bank_mask:0xf
    v_mov_b32 v63, v61
    s_nop 1
    v_add_f32_dpp v61, v63, v63 row_ror:2 row_mask:0xf bank_mask:0xf
    v_mov_b32 v63, v61
    s_nop 1
    v_add_f32_dpp v61, v63, v63 row_ror:1 row_mask:0xf bank_mask:0xf
    v_mov_b32 v63, v61
    v_mul_f32 v63, 0x3ae38e39, v63
    v_cvt_pk_bf16_f32 v61, v60, v63
    v_lshlrev_b32 v60, 16, v61
    v_and_b32 v63, 0xffff0000, v61
    v_add_f32 v63, 0x3727c5ac, v63
    v_cvt_pk_bf16_f32 v63, v63, v63
    v_and_b32 v63, 0xffff0000, v63
    v_sqrt_f32 v63, v63
    s_nop 0
    v_cvt_pk_bf16_f32 v63, v63, v63
    v_and_b32 v63, 0xffff0000, v63
    v_rcp_f32 v64, v63
    s_nop 0
    v_sub_f32 v24, v24, v60
    v_sub_f32 v25, v25, v60
    v_cvt_pk_bf16_f32 v66, v24, v25
    v_lshlrev_b32 v24, 16, v66
    v_and_b32 v25, 0xffff0000, v66
    v_mul_f32 v66, v24, v64
    v_mul_f32 v67, v25, v64
    v_fma_f32 v68, -v66, v63, v24
    v_fma_f32 v69, -v67, v63, v25
    v_fmac_f32 v66, v68, v64
    v_fmac_f32 v67, v69, v64
    v_cvt_pk_bf16_f32 v4, v66, v67
    v_sub_f32 v26, v26, v60
    v_sub_f32 v27, v27, v60
    v_cvt_pk_bf16_f32 v66, v26, v27
    v_lshlrev_b32 v26, 16, v66
    v_and_b32 v27, 0xffff0000, v66
    v_mul_f32 v66, v26, v64
    v_mul_f32 v67, v27, v64
    v_fma_f32 v68, -v66, v63, v26
    v_fma_f32 v69, -v67, v63, v27
    v_fmac_f32 v66, v68, v64
    v_fmac_f32 v67, v69, v64
    v_cvt_pk_bf16_f32 v5, v66, v67
    buffer_store_dwordx2 v[4:5], v1, s[72:75], 0 offen offset:0 sc1
    v_sub_f32 v28, v28, v60
    v_sub_f32 v29, v29, v60
    v_cvt_pk_bf16_f32 v66, v28, v29
    v_lshlrev_b32 v28, 16, v66
    v_and_b32 v29, 0xffff0000, v66
    v_mul_f32 v66, v28, v64
    v_mul_f32 v67, v29, v64
    v_fma_f32 v68, -v66, v63, v28
    v_fma_f32 v69, -v67, v63, v29
    v_fmac_f32 v66, v68, v64
    v_fmac_f32 v67, v69, v64
    v_cvt_pk_bf16_f32 v6, v66, v67
    v_sub_f32 v30, v30, v60
    v_sub_f32 v31, v31, v60
    v_cvt_pk_bf16_f32 v66, v30, v31
    v_lshlrev_b32 v30, 16, v66
    v_and_b32 v31, 0xffff0000, v66
    v_mul_f32 v66, v30, v64
    v_mul_f32 v67, v31, v64
    v_fma_f32 v68, -v66, v63, v30
    v_fma_f32 v69, -v67, v63, v31
    v_fmac_f32 v66, v68, v64
    v_fmac_f32 v67, v69, v64
    v_cvt_pk_bf16_f32 v7, v66, v67
    buffer_store_dwordx2 v[6:7], v1, s[72:75], 0 offen offset:128 sc1
    v_sub_f32 v32, v32, v60
    v_sub_f32 v33, v33, v60
    v_cvt_pk_bf16_f32 v66, v32, v33
    v_lshlrev_b32 v32, 16, v66
    v_and_b32 v33, 0xffff0000, v66
    v_mul_f32 v66, v32, v64
    v_mul_f32 v67, v33, v64
    v_fma_f32 v68, -v66, v63, v32
    v_fma_f32 v69, -v67, v63, v33
    v_fmac_f32 v66, v68, v64
    v_fmac_f32 v67, v69, v64
    v_cvt_pk_bf16_f32 v8, v66, v67
    v_sub_f32 v34, v34, v60
    v_sub_f32 v35, v35, v60
    v_cvt_pk_bf16_f32 v66, v34, v35
    v_lshlrev_b32 v34, 16, v66
    v_and_b32 v35, 0xffff0000, v66
    v_mul_f32 v66, v34, v64
    v_mul_f32 v67, v35, v64
    v_fma_f32 v68, -v66, v63, v34
    v_fma_f32 v69, -v67, v63, v35
    v_fmac_f32 v66, v68, v64
    v_fmac_f32 v67, v69, v64
    v_cvt_pk_bf16_f32 v9, v66, v67
    buffer_store_dwordx2 v[8:9], v1, s[72:75], 0 offen offset:256 sc1
    v_sub_f32 v36, v36, v60
    v_sub_f32 v37, v37, v60
    v_cvt_pk_bf16_f32 v66, v36, v37
    v_lshlrev_b32 v36, 16, v66
    v_and_b32 v37, 0xffff0000, v66
    v_mul_f32 v66, v36, v64
    v_mul_f32 v67, v37, v64
    v_fma_f32 v68, -v66, v63, v36
    v_fma_f32 v69, -v67, v63, v37
    v_fmac_f32 v66, v68, v64
    v_fmac_f32 v67, v69, v64
    v_cvt_pk_bf16_f32 v10, v66, v67
    v_sub_f32 v38, v38, v60
    v_sub_f32 v39, v39, v60
    v_cvt_pk_bf16_f32 v66, v38, v39
    v_lshlrev_b32 v38, 16, v66
    v_and_b32 v39, 0xffff0000, v66
    v_mul_f32 v66, v38, v64
    v_mul_f32 v67, v39, v64
    v_fma_f32 v68, -v66, v63, v38
    v_fma_f32 v69, -v67, v63, v39
    v_fmac_f32 v66, v68, v64
    v_fmac_f32 v67, v69, v64
    v_cvt_pk_bf16_f32 v11, v66, v67
    buffer_store_dwordx2 v[10:11], v1, s[72:75], 0 offen offset:384 sc1
    v_sub_f32 v40, v40, v60
    v_sub_f32 v41, v41, v60
    v_cvt_pk_bf16_f32 v66, v40, v41
    v_lshlrev_b32 v40, 16, v66
    v_and_b32 v41, 0xffff0000, v66
    v_mul_f32 v66, v40, v64
    v_mul_f32 v67, v41, v64
    v_fma_f32 v68, -v66, v63, v40
    v_fma_f32 v69, -v67, v63, v41
    v_fmac_f32 v66, v68, v64
    v_fmac_f32 v67, v69, v64
    v_cvt_pk_bf16_f32 v12, v66, v67
    v_sub_f32 v42, v42, v60
    v_sub_f32 v43, v43, v60
    v_cvt_pk_bf16_f32 v66, v42, v43
    v_lshlrev_b32 v42, 16, v66
    v_and_b32 v43, 0xffff0000, v66
    v_mul_f32 v66, v42, v64
    v_mul_f32 v67, v43, v64
    v_fma_f32 v68, -v66, v63, v42
    v_fma_f32 v69, -v67, v63, v43
    v_fmac_f32 v66, v68, v64
    v_fmac_f32 v67, v69, v64
    v_cvt_pk_bf16_f32 v13, v66, v67
    buffer_store_dwordx2 v[12:13], v1, s[72:75], 0 offen offset:512 sc1
    v_sub_f32 v44, v44, v60
    v_sub_f32 v45, v45, v60
    v_cvt_pk_bf16_f32 v66, v44, v45
    v_lshlrev_b32 v44, 16, v66
    v_and_b32 v45, 0xffff0000, v66
    v_mul_f32 v66, v44, v64
    v_mul_f32 v67, v45, v64
    v_fma_f32 v68, -v66, v63, v44
    v_fma_f32 v69, -v67, v63, v45
    v_fmac_f32 v66, v68, v64
    v_fmac_f32 v67, v69, v64
    v_cvt_pk_bf16_f32 v14, v66, v67
    v_sub_f32 v46, v46, v60
    v_sub_f32 v47, v47, v60
    v_cvt_pk_bf16_f32 v66, v46, v47
    v_lshlrev_b32 v46, 16, v66
    v_and_b32 v47, 0xffff0000, v66
    v_mul_f32 v66, v46, v64
    v_mul_f32 v67, v47, v64
    v_fma_f32 v68, -v66, v63, v46
    v_fma_f32 v69, -v67, v63, v47
    v_fmac_f32 v66, v68, v64
    v_fmac_f32 v67, v69, v64
    v_cvt_pk_bf16_f32 v15, v66, v67
    buffer_store_dwordx2 v[14:15], v1, s[72:75], 0 offen offset:640 sc1
    v_sub_f32 v48, v48, v60
    v_sub_f32 v49, v49, v60
    v_cvt_pk_bf16_f32 v66, v48, v49
    v_lshlrev_b32 v48, 16, v66
    v_and_b32 v49, 0xffff0000, v66
    v_mul_f32 v66, v48, v64
    v_mul_f32 v67, v49, v64
    v_fma_f32 v68, -v66, v63, v48
    v_fma_f32 v69, -v67, v63, v49
    v_fmac_f32 v66, v68, v64
    v_fmac_f32 v67, v69, v64
    v_cvt_pk_bf16_f32 v16, v66, v67
    v_sub_f32 v50, v50, v60
    v_sub_f32 v51, v51, v60
    v_cvt_pk_bf16_f32 v66, v50, v51
    v_lshlrev_b32 v50, 16, v66
    v_and_b32 v51, 0xffff0000, v66
    v_mul_f32 v66, v50, v64
    v_mul_f32 v67, v51, v64
    v_fma_f32 v68, -v66, v63, v50
    v_fma_f32 v69, -v67, v63, v51
    v_fmac_f32 v66, v68, v64
    v_fmac_f32 v67, v69, v64
    v_cvt_pk_bf16_f32 v17, v66, v67
    buffer_store_dwordx2 v[16:17], v1, s[72:75], 0 offen offset:768 sc1
    v_sub_f32 v52, v52, v60
    v_sub_f32 v53, v53, v60
    v_cvt_pk_bf16_f32 v66, v52, v53
    v_lshlrev_b32 v52, 16, v66
    v_and_b32 v53, 0xffff0000, v66
    v_mul_f32 v66, v52, v64
    v_mul_f32 v67, v53, v64
    v_fma_f32 v68, -v66, v63, v52
    v_fma_f32 v69, -v67, v63, v53
    v_fmac_f32 v66, v68, v64
    v_fmac_f32 v67, v69, v64
    v_cvt_pk_bf16_f32 v18, v66, v67
    v_sub_f32 v54, v54, v60
    v_sub_f32 v55, v55, v60
    v_cvt_pk_bf16_f32 v66, v54, v55
    v_lshlrev_b32 v54, 16, v66
    v_and_b32 v55, 0xffff0000, v66
    v_mul_f32 v66, v54, v64
    v_mul_f32 v67, v55, v64
    v_fma_f32 v68, -v66, v63, v54
    v_fma_f32 v69, -v67, v63, v55
    v_fmac_f32 v66, v68, v64
    v_fmac_f32 v67, v69, v64
    v_cvt_pk_bf16_f32 v19, v66, v67
    buffer_store_dwordx2 v[18:19], v1, s[72:75], 0 offen offset:896 sc1
    v_sub_f32 v56, v56, v60
    v_sub_f32 v57, v57, v60
    v_cvt_pk_bf16_f32 v66, v56, v57
    v_lshlrev_b32 v56, 16, v66
    v_and_b32 v57, 0xffff0000, v66
    v_mul_f32 v66, v56, v64
    v_mul_f32 v67, v57, v64
    v_fma_f32 v68, -v66, v63, v56
    v_fma_f32 v69, -v67, v63, v57
    v_fmac_f32 v66, v68, v64
    v_fmac_f32 v67, v69, v64
    v_cvt_pk_bf16_f32 v20, v66, v67
    v_sub_f32 v58, v58, v60
    v_sub_f32 v59, v59, v60
    v_cvt_pk_bf16_f32 v66, v58, v59
    v_lshlrev_b32 v58, 16, v66
    v_and_b32 v59, 0xffff0000, v66
    v_mul_f32 v66, v58, v64
    v_mul_f32 v67, v59, v64
    v_fma_f32 v68, -v66, v63, v58
    v_fma_f32 v69, -v67, v63, v59
    v_fmac_f32 v66, v68, v64
    v_fmac_f32 v67, v69, v64
    v_cvt_pk_bf16_f32 v21, v66, v67
    buffer_store_dwordx2 v[20:21], v1, s[72:75], 0 offen offset:1024 sc1
    s_waitcnt vmcnt(0)
K_lnskip:
    s_barrier
    s_cmp_lg_u32 s3, 0
    s_cbranch_scc1 K_lnsig
    v_mov_b32 v63, 0
    s_mov_b32 s101, 0
nonce_1:
    s_add_u32 s101, s101, 1
    s_cmp_ge_u32 s101, 0x40000
    s_cbranch_scc1 nonced_2
    buffer_load_dwordx2 v[60:61], v63, s[28:31], 0 offen sc1
    s_waitcnt vmcnt(0)
    v_readfirstlane_b32 s14, v60
    v_readfirstlane_b32 s15, v61
    s_or_b32 s40, s14, s15
    s_cmp_lg_u32 s40, 0
    s_cbranch_scc1 nonced_2
    s_sleep 2
    s_branch nonce_1
nonced_2:
    s_lshl_b32 s41, s35, 8
    s_lshl_b32 s40, s34, 3
    s_add_u32 s41, s41, s40
    s_add_u32 s41, s41, 0
    v_mov_b32 v60, s14
    v_mov_b32 v61, s15
    v_mov_b32 v63, 0
    s_mov_b64 exec, 1
    buffer_store_dwordx2 v[60:61], v63, s[92:95], s41 offen sc1
    s_mov_b64 exec, -1
K_lnsig:
    v_mov_b32 v64, 0
    v_mov_b32 v65, 0
    v_mov_b32 v66, 0
    v_mov_b32 v67, 0
    v_mov_b32 v68, 0
    v_mov_b32 v69, 0
    v_mov_b32 v70, 0
    v_mov_b32 v71, 0
    v_mov_b32 v72, 0
    v_mov_b32 v73, 0
    v_mov_b32 v74, 0
    v_mov_b32 v75, 0
    v_mov_b32 v76, 0
    v_mov_b32 v77, 0
    v_mov_b32 v78, 0
    v_mov_b32 v79, 0
    v_mov_b32 v80, 0
    v_mov_b32 v81, 0
    v_mov_b32 v82, 0
    v_mov_b32 v83, 0
    v_mov_b32 v84, 0
    v_mov_b32 v85, 0
    v_mov_b32 v86, 0
    v_mov_b32 v87, 0
    v_mov_b32 v88, 0
    v_mov_b32 v89, 0
    v_mov_b32 v90, 0
    v_mov_b32 v91, 0
    v_mov_b32 v92, 0
    v_mov_b32 v93, 0
    v_mov_b32 v94, 0
    v_mov_b32 v95, 0
    v_mov_b32 v96, 0
    v_mov_b32 v97, 0
    v_mov_b32 v98, 0
    v_mov_b32 v99, 0
    v_mov_b32 v100, 0
    v_mov_b32 v101, 0
    v_mov_b32 v102, 0
    v_mov_b32 v103, 0
    v_mov_b32 v104, 0
    v_mov_b32 v105, 0
    v_mov_b32 v106, 0
    v_mov_b32 v107, 0
    v_mov_b32 v108, 0
    v_mov_b32 v109, 0
    v_mov_b32 v110, 0
    v_mov_b32 v111, 0
    v_mov_b32 v112, 0
    v_mov_b32 v113, 0
    v_mov_b32 v114, 0
    v_mov_b32 v115, 0
    v_mov_b32 v116, 0
    v_mov_b32 v117, 0
    v_mov_b32 v118, 0
    v_mov_b32 v119, 0
    v_mov_b32 v120, 0
    v_mov_b32 v121, 0
    v_mov_b32 v122, 0
    v_mov_b32 v123, 0
    v_mov_b32 v124, 0
    v_mov_b32 v125, 0
    v_mov_b32 v126, 0
    v_mov_b32 v127, 0
    v_mov_b32 v128, 0
    v_mov_b32 v129, 0
    v_mov_b32 v130, 0
    v_mov_b32 v131, 0
    v_mov_b32 v132, 0
    v_mov_b32 v133, 0
    v_mov_b32 v134, 0
    v_mov_b32 v135, 0
    v_mov_b32 v136, 0
    v_mov_b32 v137, 0
    v_mov_b32 v138, 0
    v_mov_b32 v139, 0
    v_mov_b32 v140, 0
    v_mov_b32 v141, 0
    v_mov_b32 v142, 0
    v_mov_b32 v143, 0
    v_mov_b32 v144, 0
    v_mov_b32 v145, 0
    v_mov_b32 v146, 0
    v_mov_b32 v147, 0
    v_mov_b32 v148, 0
    v_mov_b32 v149, 0
    v_mov_b32 v150, 0
    v_mov_b32 v151, 0
    v_mov_b32 v152, 0
    v_mov_b32 v153, 0
    v_mov_b32 v154, 0
    v_mov_b32 v155, 0
    v_mov_b32 v156, 0
    v_mov_b32 v157, 0
    v_mov_b32 v158, 0
    v_mov_b32 v159, 0
    s_cmp_ge_u32 s65, 6
    s_cbranch_scc1 T1_KN
    v_and_b32 v60, 15, v0
    v_bfe_u32 v61, v0, 4, 2
    v_lshrrev_b32 v63, 1, v60
    s_lshl_b32 s40, s37, 6
    v_add_u32 v17, s40, v60
    v_lshlrev_b32 v17, 7, v17
    v_add_u32 v18, 0, v61
    v_xor_b32 v18, v18, v63
    v_lshl_add_u32 v1, v18, 4, v17
    v_add_u32 v18, 4, v61
    v_xor_b32 v18, v18, v63
    v_lshl_add_u32 v2, v18, 4, v17
    s_mul_i32 s40, s38, 96
    v_add_u32 v17, s40, v60
    v_lshlrev_b32 v17, 7, v17
    v_add_u32 v17, 65536, v17
    v_add_u32 v18, 0, v61
    v_xor_b32 v18, v18, v63
    v_lshl_add_u32 v5, v18, 4, v17
    v_add_u32 v18, 4, v61
    v_xor_b32 v18, v18, v63
    v_lshl_add_u32 v6, v18, 4, v17
    s_barrier
    s_mov_b32 s44, 0
    s_mov_b32 s45, 0
    s_mov_b32 s46, 0
    v_add_u32 v3, 0, v1
    v_add_u32 v4, 0, v2
    v_add_u32 v11, 0, v5
    v_add_u32 v12, 0, v6
    ds_read_b128 v[36:39], v11 offset:0
    ds_read_b128 v[40:43], v11 offset:2048
    ds_read_b128 v[44:47], v11 offset:4096
    ds_read_b128 v[20:23], v3 offset:0
    ds_read_b128 v[24:27], v3 offset:2048
    ds_read_b128 v[28:31], v3 offset:4096
    ds_read_b128 v[32:35], v3 offset:6144
T1nk_loop:
    s_waitcnt lgkmcnt(3)
    v_mfma_f32_16x16x32_bf16 v[64:67], v[36:39], v[20:23], v[64:67]
    ds_read_b128 v[48:51], v11 offset:6144
    v_mfma_f32_16x16x32_bf16 v[68:71], v[40:43], v[20:23], v[68:71]
    ds_read_b128 v[52:55], v11 offset:8192
    v_mfma_f32_16x16x32_bf16 v[80:83], v[44:47], v[20:23], v[80:83]
    ds_read_b128 v[56:59], v11 offset:10240
    s_waitcnt lgkmcnt(5)
    v_mfma_f32_16x16x32_bf16 v[72:75], v[36:39], v[24:27], v[72:75]
    v_mfma_f32_16x16x32_bf16 v[76:79], v[40:43], v[24:27], v[76:79]
    v_mfma_f32_16x16x32_bf16 v[88:91], v[44:47], v[24:27], v[88:91]
    s_waitcnt lgkmcnt(4)
    v_mfma_f32_16x16x32_bf16 v[112:115], v[36:39], v[28:31], v[112:115]
    v_mfma_f32_16x16x32_bf16 v[116:119], v[40:43], v[28:31], v[116:119]
    v_mfma_f32_16x16x32_bf16 v[128:131], v[44:47], v[28:31], v[128:131]
    s_waitcnt lgkmcnt(3)
    v_mfma_f32_16x16x32_bf16 v[120:123], v[36:39], v[32:35], v[120:123]
    v_mfma_f32_16x16x32_bf16 v[124:127], v[40:43], v[32:35], v[124:127]
    v_mfma_f32_16x16x32_bf16 v[136:139], v[44:47], v[32:35], v[136:139]
    s_waitcnt lgkmcnt(2)
    v_mfma_f32_16x16x32_bf16 v[84:87], v[48:51], v[20:23], v[84:87]
    ds_read_b128 v[36:39], v12 offset:0
    s_waitcnt lgkmcnt(2)
    v_mfma_f32_16x16x32_bf16 v[96:99], v[52:55], v[20:23], v[96:99]
    ds_read_b128 v[40:43], v12 offset:2048
    s_waitcnt lgkmcnt(2)
    v_mfma_f32_16x16x32_bf16 v[100:103], v[56:59], v[20:23], v[100:103]
    ds_read_b128 v[44:47], v12 offset:4096
    ds_read_b128 v[20:23], v4 offset:0
    v_mfma_f32_16x16x32_bf16 v[92:95], v[48:51], v[24:27], v[92:95]
    v_mfma_f32_16x16x32_bf16 v[104:107], v[52:55], v[24:27], v[104:107]
    v_mfma_f32_16x16x32_bf16 v[108:111], v[56:59], v[24:27], v[108:111]
    ds_read_b128 v[24:27], v4 offset:2048
    v_mfma_f32_16x16x32_bf16 v[132:135], v[48:51], v[28:31], v[132:135]
    v_mfma_f32_16x16x32_bf16 v[144:147], v[52:55], v[28:31], v[144:147]
    v_mfma_f32_16x16x32_bf16 v[148:151], v[56:59], v[28:31], v[148:151]
    ds_read_b128 v[28:31], v4 offset:4096
    v_mfma_f32_16x16x32_bf16 v[140:143], v[48:51], v[32:35], v[140:143]
    v_mfma_f32_16x16x32_bf16 v[152:155], v[52:55], v[32:35], v[152:155]
    v_mfma_f32_16x16x32_bf16 v[156:159], v[56:59], v[32:35], v[156:159]
    ds_read_b128 v[32:35], v4 offset:6144
    s_waitcnt lgkmcnt(3)
    v_mfma_f32_16x16x32_bf16 v[64:67], v[36:39], v[20:23], v[64:67]
    ds_read_b128 v[48:51], v12 offset:6144
    v_mfma_f32_16x16x32_bf16 v[68:71], v[40:43], v[20:23], v[68:71]
    ds_read_b128 v[52:55], v12 offset:8192
    v_mfma_f32_16x16x32_bf16 v[80:83], v[44:47], v[20:23], v[80:83]
    ds_read_b128 v[56:59], v12 offset:10240
    s_waitcnt lgkmcnt(5)
    v_mfma_f32_16x16x32_bf16 v[72:75], v[36:39], v[24:27], v[72:75]
    v_mfma_f32_16x16x32_bf16 v[76:79], v[40:43], v[24:27], v[76:79]
    v_mfma_f32_16x16x32_bf16 v[88:91], v[44:47], v[24:27], v[88:91]
    s_waitcnt lgkmcnt(4)
    v_mfma_f32_16x16x32_bf16 v[112:115], v[36:39], v[28:31], v[112:115]
    v_mfma_f32_16x16x32_bf16 v[116:119], v[40:43], v[28:31], v[116:119]
    v_mfma_f32_16x16x32_bf16 v[128:131], v[44:47], v[28:31], v[128:131]
    s_waitcnt lgkmcnt(3)
    v_mfma_f32_16x16x32_bf16 v[120:123], v[36:39], v[32:35], v[120:123]
    v_mfma_f32_16x16x32_bf16 v[124:127], v[40:43], v[32:35], v[124:127]
    v_mfma_f32_16x16x32_bf16 v[136:139], v[44:47], v[32:35], v[136:139]
    s_add_u32 s44, s44, 16384
    s_add_u32 s45, s45, 24576
    s_cmp_ge_u32 s44, 65536
    s_cselect_b32 s44, 0, s44
    s_cselect_b32 s45, 0, s45
    s_waitcnt lgkmcnt(0)
    v_add_u32 v3, s44, v1
    v_add_u32 v4, s44, v2
    v_add_u32 v11, s45, v5
    v_add_u32 v12, s45, v6
    s_barrier
    v_mfma_f32_16x16x32_bf16 v[84:87], v[48:51], v[20:23], v[84:87]
    ds_read_b128 v[36:39], v11 offset:0
    v_mfma_f32_16x16x32_bf16 v[96:99], v[52:55], v[20:23], v[96:99]
    ds_read_b128 v[40:43], v11 offset:2048
    v_mfma_f32_16x16x32_bf16 v[100:103], v[56:59], v[20:23], v[100:103]
    ds_read_b128 v[44:47], v11 offset:4096
    ds_read_b128 v[20:23], v3 offset:0
    v_mfma_f32_16x16x32_bf16 v[92:95], v[48:51], v[24:27], v[92:95]
    v_mfma_f32_16x16x32_bf16 v[104:107], v[52:55], v[24:27], v[104:107]
    v_mfma_f32_16x16x32_bf16 v[108:111], v[56:59], v[24:27], v[108:111]
    ds_read_b128 v[24:27], v3 offset:2048
    v_mfma_f32_16x16x32_bf16 v[132:135], v[48:51], v[28:31], v[132:135]
    v_mfma_f32_16x16x32_bf16 v[144:147], v[52:55], v[28:31], v[144:147]
    v_mfma_f32_16x16x32_bf16 v[148:151], v[56:59], v[28:31], v[148:151]
    ds_read_b128 v[28:31], v3 offset:4096
    v_mfma_f32_16x16x32_bf16 v[140:143], v[48:51], v[32:35], v[140:143]
    v_mfma_f32_16x16x32_bf16 v[152:155], v[52:55], v[32:35], v[152:155]
    v_mfma_f32_16x16x32_bf16 v[156:159], v[56:59], v[32:35], v[156:159]
    ds_read_b128 v[32:35], v3 offset:6144
    s_add_u32 s46, s46, 1
    s_cmp_lt_u32 s46, 9
    s_cbranch_scc1 T1nk_loop
    s_waitcnt lgkmcnt(0)
    s_nop 15
    s_branch T1_done
T1_KN:
    v_and_b32 v60, 15, v0
    v_bfe_u32 v61, v0, 4, 2
    v_lshrrev_b32 v63, 1, v60
    s_lshl_b32 s40, s37, 6
    v_add_u32 v17, s40, v60
    v_lshlrev_b32 v17, 7, v17
    v_add_u32 v18, 0, v61
    v_xor_b32 v18, v18, v63
    v_lshl_add_u32 v1, v18, 4, v17
    v_add_u32 v18, 4, v61
    v_xor_b32 v18, v18, v63
    v_lshl_add_u32 v2, v18, 4, v17
    v_lshrrev_b32 v18, 2, v60
    v_lshl_add_u32 v18, v61, 3, v18
    v_mul_u32_u24 v18, 384, v18
    v_add_u32 v18, 65536, v18
    v_and_b32 v19, 1, v60
    v_lshl_add_u32 v18, v19, 3, v18
    v_lshrrev_b32 v19, 3, v60
    v_lshlrev_b32 v19, 2, v19
    v_and_b32 v62, 1, v61
    v_lshl_or_b32 v19, v62, 1, v19
    v_bfe_u32 v62, v60, 1, 1
    s_mul_i32 s40, s38, 12
    s_add_u32 s41, s40, 0
    v_add_u32 v17, s41, v62
    v_xor_b32 v17, v17, v19
    v_lshl_add_u32 v5, v17, 4, v18
    s_add_u32 s41, s40, 2
    v_add_u32 v17, s41, v62
    v_xor_b32 v17, v17, v19
    v_lshl_add_u32 v6, v17, 4, v18
    s_add_u32 s41, s40, 4
    v_add_u32 v17, s41, v62
    v_xor_b32 v17, v17, v19
    v_lshl_add_u32 v7, v17, 4, v18
    s_add_u32 s41, s40, 6
    v_add_u32 v17, s41, v62
    v_xor_b32 v17, v17, v19
    v_lshl_add_u32 v8, v17, 4, v18
    s_add_u32 s41, s40, 8
    v_add_u32 v17, s41, v62
    v_xor_b32 v17, v17, v19
    v_lshl_add_u32 v9, v17, 4, v18
    s_add_u32 s41, s40, 10
    v_add_u32 v17, s41, v62
    v_xor_b32 v17, v17, v19
    v_lshl_add_u32 v10, v17, 4, v18
    s_barrier
    s_mov_b32 s44, 0
    s_mov_b32 s45, 0
    s_mov_b32 s46, 0
    v_add_u32 v3, 0, v1
    v_add_u32 v4, 0, v2
    v_add_u32 v11, 0, v5
    v_add_u32 v12, 0, v6
    v_add_u32 v13, 0, v7
    v_add_u32 v14, 0, v8
    v_add_u32 v15, 0, v9
    v_add_u32 v16, 0, v10
    ds_read_b64_tr_b16 v[36:37], v11 offset:0
    ds_read_b64_tr_b16 v[38:39], v11 offset:1536
    ds_read_b64_tr_b16 v[40:41], v12 offset:0
    ds_read_b128 v[20:23], v3 offset:0
    ds_read_b64_tr_b16 v[42:43], v12 offset:1536
    ds_read_b64_tr_b16 v[44:45], v13 offset:0
    ds_read_b64_tr_b16 v[46:47], v13 offset:1536
    ds_read_b128 v[24:27], v3 offset:2048
    ds_read_b128 v[28:31], v3 offset:4096
    ds_read_b128 v[32:35], v3 offset:6144
T1kn_loop:
    s_waitcnt lgkmcnt(6)
    v_mfma_f32_16x16x32_bf16 v[64:67], v[36:39], v[20:23], v[64:67]
    ds_read_b64_tr_b16 v[48:49], v14 offset:0
    s_waitcnt lgkmcnt(6)
    v_mfma_f32_16x16x32_bf16 v[68:71], v[40:43], v[20:23], v[68:71]
    ds_read_b64_tr_b16 v[50:51], v14 offset:1536
    s_waitcnt lgkmcnt(5)
    v_mfma_f32_16x16x32_bf16 v[80:83], v[44:47], v[20:23], v[80:83]
    ds_read_b64_tr_b16 v[52:53], v15 offset:0
    s_waitcnt lgkmcnt(5)
    v_mfma_f32_16x16x32_bf16 v[72:75], v[36:39], v[24:27], v[72:75]
    ds_read_b64_tr_b16 v[54:55], v15 offset:1536
    v_mfma_f32_16x16x32_bf16 v[76:79], v[40:43], v[24:27], v[76:79]
    ds_read_b64_tr_b16 v[56:57], v16 offset:0
    v_mfma_f32_16x16x32_bf16 v[88:91], v[44:47], v[24:27], v[88:91]
    ds_read_b64_tr_b16 v[58:59], v16 offset:1536
    s_waitcnt lgkmcnt(7)
    v_mfma_f32_16x16x32_bf16 v[112:115], v[36:39], v[28:31], v[112:115]
    v_mfma_f32_16x16x32_bf16 v[116:119], v[40:43], v[28:31], v[116:119]
    v_mfma_f32_16x16x32_bf16 v[128:131], v[44:47], v[28:31], v[128:131]
    s_waitcnt lgkmcnt(6)
    v_mfma_f32_16x16x32_bf16 v[120:123], v[36:39], v[32:35], v[120:123]
    v_mfma_f32_16x16x32_bf16 v[124:127], v[40:43], v[32:35], v[124:127]
    v_mfma_f32_16x16x32_bf16 v[136:139], v[44:47], v[32:35], v[136:139]
    s_waitcnt lgkmcnt(4)
    v_mfma_f32_16x16x32_bf16 v[84:87], v[48:51], v[20:23], v[84:87]
    ds_read_b64_tr_b16 v[36:37], v11 offset:12288
    s_waitcnt lgkmcnt(3)
    v_mfma_f32_16x16x32_bf16 v[96:99], v[52:55], v[20:23], v[96:99]
    ds_read_b64_tr_b16 v[38:39], v11 offset:13824
    s_waitcnt lgkmcnt(2)
    v_mfma_f32_16x16x32_bf16 v[100:103], v[56:59], v[20:23], v[100:103]
    ds_read_b64_tr_b16 v[40:41], v12 offset:12288
    ds_read_b128 v[20:23], v4 offset:0
    v_mfma_f32_16x16x32_bf16 v[92:95], v[48:51], v[24:27], v[92:95]
    ds_read_b64_tr_b16 v[42:43], v12 offset:13824
    v_mfma_f32_16x16x32_bf16 v[104:107], v[52:55], v[24:27], v[104:107]
    ds_read_b64_tr_b16 v[44:45], v13 offset:12288
    v_mfma_f32_16x16x32_bf16 v[108:111], v[56:59], v[24:27], v[108:111]
    ds_read_b64_tr_b16 v[46:47], v13 offset:13824
    ds_read_b128 v[24:27], v4 offset:2048
    v_mfma_f32_16x16x32_bf16 v[132:135], v[48:51], v[28:31], v[132:135]
    v_mfma_f32_16x16x32_bf16 v[144:147], v[52:55], v[28:31], v[144:147]
    v_mfma_f32_16x16x32_bf16 v[148:151], v[56:59], v[28:31], v[148:151]
    ds_read_b128 v[28:31], v4 offset:4096
    v_mfma_f32_16x16x32_bf16 v[140:143], v[48:51], v[32:35], v[140:143]
    v_mfma_f32_16x16x32_bf16 v[152:155], v[52:55], v[32:35], v[152:155]
    v_mfma_f32_16x16x32_bf16 v[156:159], v[56:59], v[32:35], v[156:159]
    ds_read_b128 v[32:35], v4 offset:6144
    s_waitcnt lgkmcnt(6)
    v_mfma_f32_16x16x32_bf16 v[64:67], v[36:39], v[20:23], v[64:67]
    ds_read_b64_tr_b16 v[48:49], v14 offset:12288
    s_waitcnt lgkmcnt(6)
    v_mfma_f32_16x16x32_bf16 v[68:71], v[40:43], v[20:23], v[68:71]
    ds_read_b64_tr_b16 v[50:51], v14 offset:13824
    s_waitcnt lgkmcnt(5)
    v_mfma_f32_16x16x32_bf16 v[80:83], v[44:47], v[20:23], v[80:83]
    ds_read_b64_tr_b16 v[52:53], v15 offset:12288
    s_waitcnt lgkmcnt(5)
    v_mfma_f32_16x16x32_bf16 v[72:75], v[36:39], v[24:27], v[72:75]
    ds_read_b64_tr_b16 v[54:55], v15 offset:13824
    v_mfma_f32_16x16x32_bf16 v[76:79], v[40:43], v[24:27], v[76:79]
    ds_read_b64_tr_b16 v[56:57], v16 offset:12288
    v_mfma_f32_16x16x32_bf16 v[88:91], v[44:47], v[24:27], v[88:91]
    ds_read_b64_tr_b16 v[58:59], v16 offset:13824
    s_waitcnt lgkmcnt(7)
    v_mfma_f32_16x16x32_bf16 v[112:115], v[36:39], v[28:31], v[112:115]
    v_mfma_f32_16x16x32_bf16 v[116:119], v[40:43], v[28:31], v[116:119]
    v_mfma_f32_16x16x32_bf16 v[128:131], v[44:47], v[28:31], v[128:131]
    s_waitcnt lgkmcnt(6)
    v_mfma_f32_16x16x32_bf16 v[120:123], v[36:39], v[32:35], v[120:123]
    v_mfma_f32_16x16x32_bf16 v[124:127], v[40:43], v[32:35], v[124:127]
    v_mfma_f32_16x16x32_bf16 v[136:139], v[44:47], v[32:35], v[136:139]
    s_add_u32 s44, s44, 16384
    s_add_u32 s45, s45, 24576
    s_cmp_ge_u32 s44, 65536
    s_cselect_b32 s44, 0, s44
    s_cselect_b32 s45, 0, s45
    s_waitcnt lgkmcnt(0)
    v_add_u32 v3, s44, v1
    v_add_u32 v4, s44, v2
    v_add_u32 v11, s45, v5
    v_add_u32 v12, s45, v6
    v_add_u32 v13, s45, v7
    v_add_u32 v14, s45, v8
    v_add_u32 v15, s45, v9
    v_add_u32 v16, s45, v10
    s_barrier
    v_mfma_f32_16x16x32_bf16 v[84:87], v[48:51], v[20:23], v[84:87]
    ds_read_b64_tr_b16 v[36:37], v11 offset:0
    v_mfma_f32_16x16x32_bf16 v[96:99], v[52:55], v[20:23], v[96:99]
    ds_read_b64_tr_b16 v[38:39], v11 offset:1536
    v_mfma_f32_16x16x32_bf16 v[100:103], v[56:59], v[20:23], v[100:103]
    ds_read_b64_tr_b16 v[40:41], v12 offset:0
    ds_read_b128 v[20:23], v3 offset:0
    v_mfma_f32_16x16x32_bf16 v[92:95], v[48:51], v[24:27], v[92:95]
    ds_read_b64_tr_b16 v[42:43], v12 offset:1536
    v_mfma_f32_16x16x32_bf16 v[104:107], v[52:55], v[24:27], v[104:107]
    ds_read_b64_tr_b16 v[44:45], v13 offset:0
    v_mfma_f32_16x16x32_bf16 v[108:111], v[56:59], v[24:27], v[108:111]
    ds_read_b64_tr_b16 v[46:47], v13 offset:1536
    ds_read_b128 v[24:27], v3 offset:2048
    v_mfma_f32_16x16x32_bf16 v[132:135], v[48:51], v[28:31], v[132:135]
    v_mfma_f32_16x16x32_bf16 v[144:147], v[52:55], v[28:31], v[144:147]
    v_mfma_f32_16x16x32_bf16 v[148:151], v[56:59], v[28:31], v[148:151]
    ds_read_b128 v[28:31], v3 offset:4096
    v_mfma_f32_16x16x32_bf16 v[140:143], v[48:51], v[32:35], v[140:143]
    v_mfma_f32_16x16x32_bf16 v[152:155], v[52:55], v[32:35], v[152:155]
    v_mfma_f32_16x16x32_bf16 v[156:159], v[56:59], v[32:35], v[156:159]
    ds_read_b128 v[32:35], v3 offset:6144
    s_add_u32 s46, s46, 1
    s_cmp_lt_u32 s46, 9
    s_cbranch_scc1 T1kn_loop
    s_waitcnt lgkmcnt(0)
    s_nop 15
T1_done:
    s_mov_b32 s46, s65
    s_branch K_epi
K_g1:
    s_mov_b32 s76, s16
    s_and_b32 s77, s17, 0xffff
    s_mov_b32 s78, 5308416
    s_mov_b32 s79, 0x00020000
    v_subrev_u32 v56, 256, v0
    v_mul_u32_u24 v57, 21846, v56
    v_lshrrev_b32 v57, 16, v57
    v_mul_u32_u24 v59, 3, v57
    v_sub_u32 v59, v56, v59
    s_mul_i32 s40, s64, 36
    v_add_u32 v57, s40, v57
    v_mul_u32_u24 v57, 9216, v57
    v_lshl_add_u32 v57, v59, 7, v57
    v_mov_b32 v59, 0x7f000000
    v_cmp_gt_u32 vcc, 108, v56
    s_add_u32 s40, s65, 9
    s_mul_i32 s40, s40, 384
    v_cndmask_b32 v57, v59, v57, vcc
    buffer_load_dword v160, v57, s[76:79], s40 offen
    s_cmp_lt_u32 s65, 6
    s_cbranch_scc1 K_wt2
    s_sub_u32 s40, s65, 6
    s_mul_i32 s40, s40, 384
    buffer_load_dword v160, v57, s[76:79], s40 offen
    s_branch K_wt3
K_wt2:
    s_cmp_ge_u32 s65, 3
    s_cselect_b32 s60, s12, s10
    s_cselect_b32 s61, s13, s11
    s_cselect_b32 s40, 3, 0
    s_sub_u32 s40, s65, s40
    s_mul_i32 s40, s40, 192
    s_mul_i32 s41, s64, 12
    s_add_u32 s40, s40, s41
    s_mul_i32 s40, s40, 1152
    v_lshlrev_b32 v57, 7, v56
    v_cndmask_b32 v57, v59, v57, vcc
    s_mov_b32 s76, s60
    s_and_b32 s77, s61, 0xffff
    s_mov_b32 s78, 663552
    s_mov_b32 s79, 0x00020000
    buffer_load_dword v160, v57, s[76:79], s40 offen
K_wt3:
    s_barrier
    v_mov_b32 v64, 0
    v_mov_b32 v65, 0
    v_mov_b32 v66, 0
    v_mov_b32 v67, 0
    v_mov_b32 v68, 0
    v_mov_b32 v69, 0
    v_mov_b32 v70, 0
    v_mov_b32 v71, 0
    v_mov_b32 v72, 0
    v_mov_b32 v73, 0
    v_mov_b32 v74, 0
    v_mov_b32 v75, 0
    v_mov_b32 v76, 0
    v_mov_b32 v77, 0
    v_mov_b32 v78, 0
    v_mov_b32 v79, 0
    v_mov_b32 v80, 0
    v_mov_b32 v81, 0
    v_mov_b32 v82, 0
    v_mov_b32 v83, 0
    v_mov_b32 v84, 0
    v_mov_b32 v85, 0
    v_mov_b32 v86, 0
    v_mov_b32 v87, 0
    v_mov_b32 v88, 0
    v_mov_b32 v89, 0
    v_mov_b32 v90, 0
    v_mov_b32 v91, 0
    v_mov_b32 v92, 0
    v_mov_b32 v93, 0
    v_mov_b32 v94, 0
    v_mov_b32 v95, 0
    v_mov_b32 v96, 0
    v_mov_b32 v97, 0
    v_mov_b32 v98, 0
    v_mov_b32 v99, 0
    v_mov_b32 v100, 0
    v_mov_b32 v101, 0
    v_mov_b32 v102, 0
    v_mov_b32 v103, 0
    v_mov_b32 v104, 0
    v_mov_b32 v105, 0
    v_mov_b32 v106, 0
    v_mov_b32 v107, 0
    v_mov_b32 v108, 0
    v_mov_b32 v109, 0
    v_mov_b32 v110, 0
    v_mov_b32 v111, 0
    v_mov_b32 v112, 0
    v_mov_b32 v113, 0
    v_mov_b32 v114, 0
    v_mov_b32 v115, 0
    v_mov_b32 v116, 0
    v_mov_b32 v117, 0
    v_mov_b32 v118, 0
    v_mov_b32 v119, 0
    v_mov_b32 v120, 0
    v_mov_b32 v121, 0
    v_mov_b32 v122, 0
    v_mov_b32 v123, 0
    v_mov_b32 v124, 0
    v_mov_b32 v125, 0
    v_mov_b32 v126, 0
    v_mov_b32 v127, 0
    v_mov_b32 v128, 0
    v_mov_b32 v129, 0
    v_mov_b32 v130, 0
    v_mov_b32 v131, 0
    v_mov_b32 v132, 0
    v_mov_b32 v133, 0
    v_mov_b32 v134, 0
    v_mov_b32 v135, 0
    v_mov_b32 v136, 0
    v_mov_b32 v137, 0
    v_mov_b32 v138, 0
    v_mov_b32 v139, 0
    v_mov_b32 v140, 0
    v_mov_b32 v141, 0
    v_mov_b32 v142, 0
    v_mov_b32 v143, 0
    v_mov_b32 v144, 0
    v_mov_b32 v145, 0
    v_mov_b32 v146, 0
    v_mov_b32 v147, 0
    v_mov_b32 v148, 0
    v_mov_b32 v149, 0
    v_mov_b32 v150, 0
    v_mov_b32 v151, 0
    v_mov_b32 v152, 0
    v_mov_b32 v153, 0
    v_mov_b32 v154, 0
    v_mov_b32 v155, 0
    v_mov_b32 v156, 0
    v_mov_b32 v157, 0
    v_mov_b32 v158, 0
    v_mov_b32 v159, 0
    v_and_b32 v60, 15, v0
    v_bfe_u32 v61, v0, 4, 2
    v_lshrrev_b32 v63, 1, v60
    s_lshl_b32 s40, s37, 6
    v_add_u32 v17, s40, v60
    v_lshlrev_b32 v17, 7, v17
    v_add_u32 v18, 0, v61
    v_xor_b32 v18, v18, v63
    v_lshl_add_u32 v1, v18, 4, v17
    v_add_u32 v18, 4, v61
    v_xor_b32 v18, v18, v63
    v_lshl_add_u32 v2, v18, 4, v17
    v_lshrrev_b32 v18, 2, v60
    v_lshl_add_u32 v18, v61, 3, v18
    v_mul_u32_u24 v18, 384, v18
    v_add_u32 v18, 65536, v18
    v_and_b32 v19, 1, v60
    v_lshl_add_u32 v18, v19, 3, v18
    v_lshrrev_b32 v19, 3, v60
    v_lshlrev_b32 v19, 2, v19
    v_and_b32 v62, 1, v61
    v_lshl_or_b32 v19, v62, 1, v19
    v_bfe_u32 v62, v60, 1, 1
    s_mul_i32 s40, s38, 12
    s_add_u32 s41, s40, 0
    v_add_u32 v17, s41, v62
    v_xor_b32 v17, v17, v19
    v_lshl_add_u32 v5, v17, 4, v18
    s_add_u32 s41, s40, 2
    v_add_u32 v17, s41, v62
    v_xor_b32 v17, v17, v19
    v_lshl_add_u32 v6, v17, 4, v18
    s_add_u32 s41, s40, 4
    v_add_u32 v17, s41, v62
    v_xor_b32 v17, v17, v19
    v_lshl_add_u32 v7, v17, 4, v18
    s_add_u32 s41, s40, 6
    v_add_u32 v17, s41, v62
    v_xor_b32 v17, v17, v19
    v_lshl_add_u32 v8, v17, 4, v18
    s_add_u32 s41, s40, 8
    v_add_u32 v17, s41, v62
    v_xor_b32 v17, v17, v19
    v_lshl_add_u32 v9, v17, 4, v18
    s_add_u32 s41, s40, 10
    v_add_u32 v17, s41, v62
    v_xor_b32 v17, v17, v19
    v_lshl_add_u32 v10, v17, 4, v18
    s_barrier
    v_and_b32 v162, 63, v0
    s_mul_i32 s40, s39, 43
    v_add_u32 v163, s40, v162
    s_lshl_b32 s40, s32, 7
    v_add_u32 v161, s40, v163
    v_lshlrev_b32 v161, 12, v161
    v_mov_b32 v164, 0x7f000000
    v_cmp_gt_u32 vcc, 43, v162
    s_nop 1
    v_cndmask_b32 v161, v164, v161, vcc
    v_cmp_gt_u32 vcc, 128, v163
    s_nop 1
    v_cndmask_b32 v161, v164, v161, vcc
    s_mov_b32 s78, 8388608
    s_mov_b32 s79, 0x00020000
    s_barrier
    s_cmp_lg_u32 s3, 4
    s_cbranch_scc1 tch_3
    s_cmp_le_u32 s66, 0
    s_cbranch_scc1 tch_3
    s_mul_i32 s40, s26, 13
    s_add_u32 s40, s40, 0
    s_cmp_lt_u32 s40, 32
    s_cselect_b32 s76, s6, s8
    s_cselect_b32 s77, s7, s9
    s_and_b32 s77, s77, 0xffff
    s_and_b32 s40, s40, 31
    s_lshl_b32 s40, s40, 7
    buffer_load_dword v160, v161, s[76:79], s40 offen
tch_3:
    s_barrier
    s_cmp_lg_u32 s3, 5
    s_cbranch_scc1 tch_4
    s_cmp_le_u32 s66, 1
    s_cbranch_scc1 tch_4
    s_mul_i32 s40, s26, 13
    s_add_u32 s40, s40, 1
    s_cmp_lt_u32 s40, 32
    s_cselect_b32 s76, s6, s8
    s_cselect_b32 s77, s7, s9
    s_and_b32 s77, s77, 0xffff
    s_and_b32 s40, s40, 31
    s_lshl_b32 s40, s40, 7
    buffer_load_dword v160, v161, s[76:79], s40 offen
tch_4:
    s_barrier
    s_barrier
    s_cmp_lg_u32 s3, 6
    s_cbranch_scc1 tch_5
    s_cmp_le_u32 s66, 2
    s_cbranch_scc1 tch_5
    s_mul_i32 s40, s26, 13
    s_add_u32 s40, s40, 2
    s_cmp_lt_u32 s40, 32
    s_cselect_b32 s76, s6, s8
    s_cselect_b32 s77, s7, s9
    s_and_b32 s77, s77, 0xffff
    s_and_b32 s40, s40, 31
    s_lshl_b32 s40, s40, 7
    buffer_load_dword v160, v161, s[76:79], s40 offen
tch_5:
    s_barrier
    s_cmp_lg_u32 s3, 7
    s_cbranch_scc1 tch_6
    s_cmp_le_u32 s66, 3
    s_cbranch_scc1 tch_6
    s_mul_i32 s40, s26, 13
    s_add_u32 s40, s40, 3
    s_cmp_lt_u32 s40, 32
    s_cselect_b32 s76, s6, s8
    s_cselect_b32 s77, s7, s9
    s_and_b32 s77, s77, 0xffff
    s_and_b32 s40, s40, 31
    s_lshl_b32 s40, s40, 7
    buffer_load_dword v160, v161, s[76:79], s40 offen
tch_6:
    s_barrier
    s_barrier
    s_cmp_lg_u32 s3, 4
    s_cbranch_scc1 tch_7
    s_cmp_le_u32 s66, 4
    s_cbranch_scc1 tch_7
    s_mul_i32 s40, s26, 13
    s_add_u32 s40, s40, 4
    s_cmp_lt_u32 s40, 32
    s_cselect_b32 s76, s6, s8
    s_cselect_b32 s77, s7, s9
    s_and_b32 s77, s77, 0xffff
    s_and_b32 s40, s40, 31
    s_lshl_b32 s40, s40, 7
    buffer_load_dword v160, v161, s[76:79], s40 offen
tch_7:
    s_barrier
    s_cmp_lg_u32 s3, 5
    s_cbranch_scc1 tch_8
    s_cmp_le_u32 s66, 5
    s_cbranch_scc1 tch_8
    s_mul_i32 s40, s26, 13
    s_add_u32 s40, s40, 5
    s_cmp_lt_u32 s40, 32
    s_cselect_b32 s76, s6, s8
    s_cselect_b32 s77, s7, s9
    s_and_b32 s77, s77, 0xffff
    s_and_b32 s40, s40, 31
    s_lshl_b32 s40, s40, 7
    buffer_load_dword v160, v161, s[76:79], s40 offen
tch_8:
    s_barrier
    s_mov_b32 s44, 16384
    s_mov_b32 s45, 24576
    s_mov_b32 s46, 0
    v_add_u32 v3, 16384, v1
    v_add_u32 v4, 16384, v2
    v_add_u32 v11, 24576, v5
    v_add_u32 v12, 24576, v6
    v_add_u32 v13, 24576, v7
    v_add_u32 v14, 24576, v8
    v_add_u32 v15, 24576, v9
    v_add_u32 v16, 24576, v10
    ds_read_b64_tr_b16 v[36:37], v11 offset:0
    ds_read_b64_tr_b16 v[38:39], v11 offset:1536
    ds_read_b64_tr_b16 v[40:41], v12 offset:0
    ds_read_b128 v[20:23], v3 offset:0
    ds_read_b64_tr_b16 v[42:43], v12 offset:1536
    ds_read_b64_tr_b16 v[44:45], v13 offset:0
    ds_read_b64_tr_b16 v[46:47], v13 offset:1536
    ds_read_b128 v[24:27], v3 offset:2048
    ds_read_b128 v[28:31], v3 offset:4096
    ds_read_b128 v[32:35], v3 offset:6144
T2_loop:
    s_waitcnt lgkmcnt(6)
    v_mfma_f32_16x16x32_bf16 v[64:67], v[36:39], v[20:23], v[64:67]
    ds_read_b64_tr_b16 v[48:49], v14 offset:0
    s_waitcnt lgkmcnt(6)
    v_mfma_f32_16x16x32_bf16 v[68:71], v[40:43], v[20:23], v[68:71]
    ds_read_b64_tr_b16 v[50:51], v14 offset:1536
    s_waitcnt lgkmcnt(5)
    v_mfma_f32_16x16x32_bf16 v[80:83], v[44:47], v[20:23], v[80:83]
    ds_read_b64_tr_b16 v[52:53], v15 offset:0
    s_waitcnt lgkmcnt(5)
    v_mfma_f32_16x16x32_bf16 v[72:75], v[36:39], v[24:27], v[72:75]
    ds_read_b64_tr_b16 v[54:55], v15 offset:1536
    v_mfma_f32_16x16x32_bf16 v[76:79], v[40:43], v[24:27], v[76:79]
    ds_read_b64_tr_b16 v[56:57], v16 offset:0
    v_mfma_f32_16x16x32_bf16 v[88:91], v[44:47], v[24:27], v[88:91]
    ds_read_b64_tr_b16 v[58:59], v16 offset:1536
    s_waitcnt lgkmcnt(7)
    v_mfma_f32_16x16x32_bf16 v[112:115], v[36:39], v[28:31], v[112:115]
    v_mfma_f32_16x16x32_bf16 v[116:119], v[40:43], v[28:31], v[116:119]
    v_mfma_f32_16x16x32_bf16 v[128:131], v[44:47], v[28:31], v[128:131]
    s_waitcnt lgkmcnt(6)
    v_mfma_f32_16x16x32_bf16 v[120:123], v[36:39], v[32:35], v[120:123]
    v_mfma_f32_16x16x32_bf16 v[124:127], v[40:43], v[32:35], v[124:127]
    v_mfma_f32_16x16x32_bf16 v[136:139], v[44:47], v[32:35], v[136:139]
    s_waitcnt lgkmcnt(4)
    v_mfma_f32_16x16x32_bf16 v[84:87], v[48:51], v[20:23], v[84:87]
    ds_read_b64_tr_b16 v[36:37], v11 offset:12288
    s_waitcnt lgkmcnt(3)
    v_mfma_f32_16x16x32_bf16 v[96:99], v[52:55], v[20:23], v[96:99]
    ds_read_b64_tr_b16 v[38:39], v11 offset:13824
    s_waitcnt lgkmcnt(2)
    v_mfma_f32_16x16x32_bf16 v[100:103], v[56:59], v[20:23], v[100:103]
    ds_read_b64_tr_b16 v[40:41], v12 offset:12288
    ds_read_b128 v[20:23], v4 offset:0
    v_mfma_f32_16x16x32_bf16 v[92:95], v[48:51], v[24:27], v[92:95]
    ds_read_b64_tr_b16 v[42:43], v12 offset:13824
    v_mfma_f32_16x16x32_bf16 v[104:107], v[52:55], v[24:27], v[104:107]
    ds_read_b64_tr_b16 v[44:45], v13 offset:12288
    v_mfma_f32_16x16x32_bf16 v[108:111], v[56:59], v[24:27], v[108:111]
    ds_read_b64_tr_b16 v[46:47], v13 offset:13824
    ds_read_b128 v[24:27], v4 offset:2048
    v_mfma_f32_16x16x32_bf16 v[132:135], v[48:51], v[28:31], v[132:135]
    v_mfma_f32_16x16x32_bf16 v[144:147], v[52:55], v[28:31], v[144:147]
    v_mfma_f32_16x16x32_bf16 v[148:151], v[56:59], v[28:31], v[148:151]
    ds_read_b128 v[28:31], v4 offset:4096
    v_mfma_f32_16x16x32_bf16 v[140:143], v[48:51], v[32:35], v[140:143]
    v_mfma_f32_16x16x32_bf16 v[152:155], v[52:55], v[32:35], v[152:155]
    v_mfma_f32_16x16x32_bf16 v[156:159], v[56:59], v[32:35], v[156:159]
    ds_read_b128 v[32:35], v4 offset:6144
    s_waitcnt lgkmcnt(6)
    v_mfma_f32_16x16x32_bf16 v[64:67], v[36:39], v[20:23], v[64:67]
    ds_read_b64_tr_b16 v[48:49], v14 offset:12288
    s_waitcnt lgkmcnt(6)
    v_mfma_f32_16x16x32_bf16 v[68:71], v[40:43], v[20:23], v[68:71]
    ds_read_b64_tr_b16 v[50:51], v14 offset:13824
    s_waitcnt lgkmcnt(5)
    v_mfma_f32_16x16x32_bf16 v[80:83], v[44:47], v[20:23], v[80:83]
    ds_read_b64_tr_b16 v[52:53], v15 offset:12288
    s_waitcnt lgkmcnt(5)
    v_mfma_f32_16x16x32_bf16 v[72:75], v[36:39], v[24:27], v[72:75]
    ds_read_b64_tr_b16 v[54:55], v15 offset:13824
    v_mfma_f32_16x16x32_bf16 v[76:79], v[40:43], v[24:27], v[76:79]
    ds_read_b64_tr_b16 v[56:57], v16 offset:12288
    v_mfma_f32_16x16x32_bf16 v[88:91], v[44:47], v[24:27], v[88:91]
    ds_read_b64_tr_b16 v[58:59], v16 offset:13824
    s_waitcnt lgkmcnt(7)
    v_mfma_f32_16x16x32_bf16 v[112:115], v[36:39], v[28:31], v[112:115]
    v_mfma_f32_16x16x32_bf16 v[116:119], v[40:43], v[28:31], v[116:119]
    v_mfma_f32_16x16x32_bf16 v[128:131], v[44:47], v[28:31], v[128:131]
    s_waitcnt lgkmcnt(6)
    v_mfma_f32_16x16x32_bf16 v[120:123], v[36:39], v[32:35], v[120:123]
    v_mfma_f32_16x16x32_bf16 v[124:127], v[40:43], v[32:35], v[124:127]
    v_mfma_f32_16x16x32_bf16 v[136:139], v[44:47], v[32:35], v[136:139]
    s_add_u32 s44, s44, 16384
    s_add_u32 s45, s45, 24576
    s_cmp_ge_u32 s44, 65536
    s_cselect_b32 s44, 0, s44
    s_cselect_b32 s45, 0, s45
    s_waitcnt lgkmcnt(0)
    v_add_u32 v3, s44, v1
    v_add_u32 v4, s44, v2
    v_add_u32 v11, s45, v5
    v_add_u32 v12, s45, v6
    v_add_u32 v13, s45, v7
    v_add_u32 v14, s45, v8
    v_add_u32 v15, s45, v9
    v_add_u32 v16, s45, v10
    s_barrier
    v_mfma_f32_16x16x32_bf16 v[84:87], v[48:51], v[20:23], v[84:87]
    ds_read_b64_tr_b16 v[36:37], v11 offset:0
    v_mfma_f32_16x16x32_bf16 v[96:99], v[52:55], v[20:23], v[96:99]
    ds_read_b64_tr_b16 v[38:39], v11 offset:1536
    v_mfma_f32_16x16x32_bf16 v[100:103], v[56:59], v[20:23], v[100:103]
    ds_read_b64_tr_b16 v[40:41], v12 offset:0
    ds_read_b128 v[20:23], v3 offset:0
    v_mfma_f32_16x16x32_bf16 v[92:95], v[48:51], v[24:27], v[92:95]
    ds_read_b64_tr_b16 v[42:43], v12 offset:1536
    v_mfma_f32_16x16x32_bf16 v[104:107], v[52:55], v[24:27], v[104:107]
    ds_read_b64_tr_b16 v[44:45], v13 offset:0
    v_mfma_f32_16x16x32_bf16 v[108:111], v[56:59], v[24:27], v[108:111]
    ds_read_b64_tr_b16 v[46:47], v13 offset:1536
    ds_read_b128 v[24:27], v3 offset:2048
    v_mfma_f32_16x16x32_bf16 v[132:135], v[48:51], v[28:31], v[132:135]
    v_mfma_f32_16x16x32_bf16 v[144:147], v[52:55], v[28:31], v[144:147]
    v_mfma_f32_16x16x32_bf16 v[148:151], v[56:59], v[28:31], v[148:151]
    ds_read_b128 v[28:31], v3 offset:4096
    v_mfma_f32_16x16x32_bf16 v[140:143], v[48:51], v[32:35], v[140:143]
    v_mfma_f32_16x16x32_bf16 v[152:155], v[52:55], v[32:35], v[152:155]
    v_mfma_f32_16x16x32_bf16 v[156:159], v[56:59], v[32:35], v[156:159]
    ds_read_b128 v[32:35], v3 offset:6144
    s_add_u32 s46, s46, 1
    s_cmp_lt_u32 s46, 9
    s_cbranch_scc1 T2_loop
    s_waitcnt lgkmcnt(0)
    s_nop 15
    s_mov_b32 s76, s18
    s_and_b32 s77, s19, 0xffff
    s_mov_b32 s78, 5308416
    s_mov_b32 s79, 0x00020000
    s_cmp_ge_u32 s3, 7
    s_cbranch_scc1 w2t_9
    v_and_b32 v162, 63, v0
    v_mul_u32_u24 v163, 5462, v162
    v_lshrrev_b32 v163, 16, v163
    v_mul_u32_u24 v164, 12, v163
    v_sub_u32 v164, v162, v164
    v_mul_u32_u24 v165, 21846, v164
    v_lshrrev_b32 v165, 16, v165
    v_mul_u32_u24 v166, 3, v165
    v_sub_u32 v166, v164, v166
    s_sub_u32 s40, s3, 4
    s_mul_i32 s40, s40, 5
    v_add_u32 v163, s40, v163
    s_sub_u32 s44, s67, s66
    v_cmp_gt_u32 vcc, s44, v163
    v_cmp_gt_u32 s[44:45], 60, v162
    s_mul_i32 s40, s26, 14
    s_cmp_eq_u32 s26, 4
    s_addc_u32 s40, s40, 0
    s_and_b64 vcc, vcc, s[44:45]
    v_add_u32 v163, s40, v163
    v_lshlrev_b32 v163, 6, v163
    s_lshl_b32 s40, s32, 2
    v_add3_u32 v163, v163, v165, s40
    v_mul_u32_u24 v163, 1152, v163
    v_lshl_add_u32 v163, v166, 7, v163
    v_mov_b32 v164, 0x7f000000
    v_cndmask_b32 v163, v164, v163, vcc
    s_mul_i32 s40, s39, 384
    buffer_load_dword v160, v163, s[76:79], s40 offen
w2t_9:
    s_add_u32 s46, s65, 15
K_epi:
    s_add_u32 s68, s24, 4194304
    s_addc_u32 s69, s25, 0
    s_and_b32 s69, s69, 0xffff
    s_mov_b32 s70, 4718592
    s_mov_b32 s71, 0x00020000
    s_add_u32 s72, s24, 16777216
    s_addc_u32 s73, s25, 0
    s_and_b32 s73, s73, 0xffff
    s_mov_b32 s74, 25165824
    s_mov_b32 s75, 0x00020000
    s_lshl_b32 s49, s64, 7
    s_cmp_ge_u32 s46, 6
    s_cbranch_scc1 E_h
    s_mov_b32 s43, 0x80008000
    s_cmp_ge_u32 s46, 3
    s_cselect_b32 s42, 0x80008000, 0
    s_cselect_b32 s41, 2048, 0
    s_cselect_b32 s40, 3, 0
    s_add_u32 s49, s49, s41
    s_sub_u32 s40, s46, s40
    s_mul_i32 s48, s40, 192
    s_mov_b32 s47, 1152
    s_lshl_b32 s41, s40, 8
    s_lshl_b32 s40, s64, 3
    s_add_u32 s41, s41, s40
    s_cmp_ge_u32 s46, 3
    s_cselect_b32 s40, 128, 0
    s_add_u32 s41, s41, s40
    s_add_u32 s41, s41, 2048
    s_branch E_go
E_h:
    s_mov_b32 s42, 0
    s_mov_b32 s43, 0
    s_mov_b32 s68, s72
    s_mov_b32 s69, s73
    s_mov_b32 s70, s74
    s_sub_u32 s40, s46, 6
    s_mul_i32 s48, s40, 192
    s_mov_b32 s47, 4096
    s_lshl_b32 s41, s64, 8
    s_lshl_b32 s40, s40, 3
    s_add_u32 s41, s41, s40
    s_add_u32 s41, s41, 4096
E_go:
    s_lshl_b32 s40, s37, 6
    s_add_u32 s49, s49, s40
    s_mul_i32 s40, s38, 96
    s_add_u32 s48, s48, s40
    v_and_b32 v60, 15, v0
    v_add_u32 v60, s49, v60
    v_mul_lo_u32 v60, v60, s47
    v_bfe_u32 v61, v0, 4, 1
    v_bfe_u32 v62, v0, 5, 1
    v_lshlrev_b32 v61, 4, v61
    v_lshl_add_u32 v61, v62, 3, v61
    v_add_u32 v61, s48, v61
    v_add_u32 v62, 0, v61
    v_lshrrev_b32 v63, 11, v62
    v_lshlrev_b32 v63, 23, v63
    v_and_b32 v62, 2047, v62
    v_add_u32 v63, v60, v63
    v_lshl_add_u32 v2, v62, 1, v63
    v_add_u32 v62, 32, v61
    v_lshrrev_b32 v63, 11, v62
    v_lshlrev_b32 v63, 23, v63
    v_and_b32 v62, 2047, v62
    v_add_u32 v63, v60, v63
    v_lshl_add_u32 v3, v62, 1, v63
    v_add_u32 v62, 64, v61
    v_lshrrev_b32 v63, 11, v62
    v_lshlrev_b32 v63, 23, v63
    v_and_b32 v62, 2047, v62
    v_add_u32 v63, v60, v63
    v_lshl_add_u32 v4, v62, 1, v63
    s_mul_i32 s44, s47, 0
    s_mul_i32 s45, s47, 16
    v_cvt_pk_bf16_f32 v20, v64, v65
    v_cvt_pk_bf16_f32 v21, v66, v67
    v_cvt_pk_bf16_f32 v22, v68, v69
    v_cvt_pk_bf16_f32 v23, v70, v71
    v_cvt_pk_bf16_f32 v24, v72, v73
    v_cvt_pk_bf16_f32 v25, v74, v75
    v_cvt_pk_bf16_f32 v26, v76, v77
    v_cvt_pk_bf16_f32 v27, v78, v79
    v_pk_max_i16 v20, v20, s43
    v_pk_max_i16 v21, v21, s43
    v_pk_max_i16 v22, v22, s43
    v_pk_max_i16 v23, v23, s43
    v_pk_max_i16 v24, v24, s43
    v_pk_max_i16 v25, v25, s43
    v_pk_max_i16 v26, v26, s43
    v_pk_max_i16 v27, v27, s43
    v_xor_b32 v20, s42, v20
    v_xor_b32 v21, s42, v21
    v_xor_b32 v22, s42, v22
    v_xor_b32 v23, s42, v23
    v_xor_b32 v24, s42, v24
    v_xor_b32 v25, s42, v25
    v_xor_b32 v26, s42, v26
    v_xor_b32 v27, s42, v27
    s_nop 1
    v_permlane16_swap_b32 v20, v22
    v_permlane16_swap_b32 v21, v23
    v_permlane16_swap_b32 v24, v26
    v_permlane16_swap_b32 v25, v27
    buffer_store_dwordx4 v[20:23], v2, s[68:71], s44 offen sc1
    buffer_store_dwordx4 v[24:27], v2, s[68:71], s45 offen sc1
    s_cmp_lt_u32 s46, 6
    s_cbranch_scc1 Esk_10
    s_barrier
Esk_10:
    v_cvt_pk_bf16_f32 v28, v80, v81
    v_cvt_pk_bf16_f32 v29, v82, v83
    v_cvt_pk_bf16_f32 v30, v84, v85
    v_cvt_pk_bf16_f32 v31, v86, v87
    v_cvt_pk_bf16_f32 v32, v88, v89
    v_cvt_pk_bf16_f32 v33, v90, v91
    v_cvt_pk_bf16_f32 v34, v92, v93
    v_cvt_pk_bf16_f32 v35, v94, v95
    v_pk_max_i16 v28, v28, s43
    v_pk_max_i16 v29, v29, s43
    v_pk_max_i16 v30, v30, s43
    v_pk_max_i16 v31, v31, s43
    v_pk_max_i16 v32, v32, s43
    v_pk_max_i16 v33, v33, s43
    v_pk_max_i16 v34, v34, s43
    v_pk_max_i16 v35, v35, s43
    v_xor_b32 v28, s42, v28
    v_xor_b32 v29, s42, v29
    v_xor_b32 v30, s42, v30
    v_xor_b32 v31, s42, v31
    v_xor_b32 v32, s42, v32
    v_xor_b32 v33, s42, v33
    v_xor_b32 v34, s42, v34
    v_xor_b32 v35, s42, v35
    s_nop 1
    v_permlane16_swap_b32 v28, v30
    v_permlane16_swap_b32 v29, v31
    v_permlane16_swap_b32 v32, v34
    v_permlane16_swap_b32 v33, v35
    buffer_store_dwordx4 v[28:31], v3, s[68:71], s44 offen sc1
    buffer_store_dwordx4 v[32:35], v3, s[68:71], s45 offen sc1
    s_cmp_lt_u32 s46, 6
    s_cbranch_scc1 Esk_11
    s_barrier
Esk_11:
    v_cvt_pk_bf16_f32 v20, v96, v97
    v_cvt_pk_bf16_f32 v21, v98, v99
    v_cvt_pk_bf16_f32 v22, v100, v101
    v_cvt_pk_bf16_f32 v23, v102, v103
    v_cvt_pk_bf16_f32 v24, v104, v105
    v_cvt_pk_bf16_f32 v25, v106, v107
    v_cvt_pk_bf16_f32 v26, v108, v109
    v_cvt_pk_bf16_f32 v27, v110, v111
    v_pk_max_i16 v20, v20, s43
    v_pk_max_i16 v21, v21, s43
    v_pk_max_i16 v22, v22, s43
    v_pk_max_i16 v23, v23, s43
    v_pk_max_i16 v24, v24, s43
    v_pk_max_i16 v25, v25, s43
    v_pk_max_i16 v26, v26, s43
    v_pk_max_i16 v27, v27, s43
    v_xor_b32 v20, s42, v20
    v_xor_b32 v21, s42, v21
    v_xor_b32 v22, s42, v22
    v_xor_b32 v23, s42, v23
    v_xor_b32 v24, s42, v24
    v_xor_b32 v25, s42, v25
    v_xor_b32 v26, s42, v26
    v_xor_b32 v27, s42, v27
    s_nop 1
    v_permlane16_swap_b32 v20, v22
    v_permlane16_swap_b32 v21, v23
    v_permlane16_swap_b32 v24, v26
    v_permlane16_swap_b32 v25, v27
    buffer_store_dwordx4 v[20:23], v4, s[68:71], s44 offen sc1
    buffer_store_dwordx4 v[24:27], v4, s[68:71], s45 offen sc1
    s_barrier
    s_mul_i32 s44, s47, 32
    s_mul_i32 s45, s47, 48
    v_cvt_pk_bf16_f32 v20, v112, v113
    v_cvt_pk_bf16_f32 v21, v114, v115
    v_cvt_pk_bf16_f32 v22, v116, v117
    v_cvt_pk_bf16_f32 v23, v118, v119
    v_cvt_pk_bf16_f32 v24, v120, v121
    v_cvt_pk_bf16_f32 v25, v122, v123
    v_cvt_pk_bf16_f32 v26, v124, v125
    v_cvt_pk_bf16_f32 v27, v126, v127
    v_pk_max_i16 v20, v20, s43
    v_pk_max_i16 v21, v21, s43
    v_pk_max_i16 v22, v22, s43
    v_pk_max_i16 v23, v23, s43
    v_pk_max_i16 v24, v24, s43
    v_pk_max_i16 v25, v25, s43
    v_pk_max_i16 v26, v26, s43
    v_pk_max_i16 v27, v27, s43
    v_xor_b32 v20, s42, v20
    v_xor_b32 v21, s42, v21
    v_xor_b32 v22, s42, v22
    v_xor_b32 v23, s42, v23
    v_xor_b32 v24, s42, v24
    v_xor_b32 v25, s42, v25
    v_xor_b32 v26, s42, v26
    v_xor_b32 v27, s42, v27
    s_nop 1
    v_permlane16_swap_b32 v20, v22
    v_permlane16_swap_b32 v21, v23
    v_permlane16_swap_b32 v24, v26
    v_permlane16_swap_b32 v25, v27
    buffer_store_dwordx4 v[20:23], v2, s[68:71], s44 offen sc1
    buffer_store_dwordx4 v[24:27], v2, s[68:71], s45 offen sc1
    s_cmp_lt_u32 s46, 6
    s_cbranch_scc1 Esk_12
    s_barrier
Esk_12:
    v_cvt_pk_bf16_f32 v28, v128, v129
    v_cvt_pk_bf16_f32 v29, v130, v131
    v_cvt_pk_bf16_f32 v30, v132, v133
    v_cvt_pk_bf16_f32 v31, v134, v135
    v_cvt_pk_bf16_f32 v32, v136, v137
    v_cvt_pk_bf16_f32 v33, v138, v139
    v_cvt_pk_bf16_f32 v34, v140, v141
    v_cvt_pk_bf16_f32 v35, v142, v143
    v_pk_max_i16 v28, v28, s43
    v_pk_max_i16 v29, v29, s43
    v_pk_max_i16 v30, v30, s43
    v_pk_max_i16 v31, v31, s43
    v_pk_max_i16 v32, v32, s43
    v_pk_max_i16 v33, v33, s43
    v_pk_max_i16 v34, v34, s43
    v_pk_max_i16 v35, v35, s43
    v_xor_b32 v28, s42, v28
    v_xor_b32 v29, s42, v29
    v_xor_b32 v30, s42, v30
    v_xor_b32 v31, s42, v31
    v_xor_b32 v32, s42, v32
    v_xor_b32 v33, s42, v33
    v_xor_b32 v34, s42, v34
    v_xor_b32 v35, s42, v35
    s_nop 1
    v_permlane16_swap_b32 v28, v30
    v_permlane16_swap_b32 v29, v31
    v_permlane16_swap_b32 v32, v34
    v_permlane16_swap_b32 v33, v35
    buffer_store_dwordx4 v[28:31], v3, s[68:71], s44 offen sc1
    buffer_store_dwordx4 v[32:35], v3, s[68:71], s45 offen sc1
    s_cmp_lt_u32 s46, 6
    s_cbranch_scc1 Esk_13
    s_barrier
Esk_13:
    v_cvt_pk_bf16_f32 v20, v144, v145
    v_cvt_pk_bf16_f32 v21, v146, v147
    v_cvt_pk_bf16_f32 v22, v148, v149
    v_cvt_pk_bf16_f32 v23, v150, v151
    v_cvt_pk_bf16_f32 v24, v152, v153
    v_cvt_pk_bf16_f32 v25, v154, v155
    v_cvt_pk_bf16_f32 v26, v156, v157
    v_cvt_pk_bf16_f32 v27, v158, v159
    v_pk_max_i16 v20, v20, s43
    v_pk_max_i16 v21, v21, s43
    v_pk_max_i16 v22, v22, s43
    v_pk_max_i16 v23, v23, s43
    v_pk_max_i16 v24, v24, s43
    v_pk_max_i16 v25, v25, s43
    v_pk_max_i16 v26, v26, s43
    v_pk_max_i16 v27, v27, s43
    v_xor_b32 v20, s42, v20
    v_xor_b32 v21, s42, v21
    v_xor_b32 v22, s42, v22
    v_xor_b32 v23, s42, v23
    v_xor_b32 v24, s42, v24
    v_xor_b32 v25, s42, v25
    v_xor_b32 v26, s42, v26
    v_xor_b32 v27, s42, v27
    s_nop 1
    v_permlane16_swap_b32 v20, v22
    v_permlane16_swap_b32 v21, v23
    v_permlane16_swap_b32 v24, v26
    v_permlane16_swap_b32 v25, v27
    buffer_store_dwordx4 v[20:23], v4, s[68:71], s44 offen sc1
    buffer_store_dwordx4 v[24:27], v4, s[68:71], s45 offen sc1
    s_barrier
    s_mov_b32 s90, -1
    s_cmp_ge_u32 s3, 4
    s_cbranch_scc1 E_na
    s_cmp_lt_u32 s46, 6
    s_cbranch_scc1 E_na
    s_mov_b32 s90, s41
    s_mov_b32 s45, 3
    s_branch E_g0
E_na:
    s_mov_b32 s44, 5
    s_cmp_lt_u32 s46, 6
    s_cselect_b32 s44, 2, s44
    s_cmp_ge_u32 s3, 4
    s_cselect_b32 s44, 2, s44
    s_sub_u32 s45, 6, s44
E_w1:
    s_barrier
    s_sub_u32 s44, s44, 1
    s_cmp_lg_u32 s44, 0
    s_cbranch_scc1 E_w1
    s_waitcnt vmcnt(0)
    s_barrier
    s_and_b32 s40, s3, 3
    s_cmp_lg_u32 s40, 0
    s_cbranch_scc1 E_sig
    s_cmp_eq_u32 s3, 0
    s_cbranch_scc1 E_sig0
    v_mov_b32 v63, 0
    s_mov_b32 s101, 0
nonce_14:
    s_add_u32 s101, s101, 1
    s_cmp_ge_u32 s101, 0x40000
    s_cbranch_scc1 nonced_15
    buffer_load_dwordx2 v[60:61], v63, s[28:31], 0 offen sc1
    s_waitcnt vmcnt(0)
    v_readfirstlane_b32 s14, v60
    v_readfirstlane_b32 s15, v61
    s_or_b32 s40, s14, s15
    s_cmp_lg_u32 s40, 0
    s_cbranch_scc1 nonced_15
    s_sleep 2
    s_branch nonce_14
nonced_15:
E_sig0:
    v_mov_b32 v60, s14
    v_mov_b32 v61, s15
    v_mov_b32 v63, 0
    s_mov_b64 exec, 1
    buffer_store_dwordx2 v[60:61], v63, s[92:95], s41 offen sc1
    s_mov_b64 exec, -1
E_sig:
    s_cmp_lt_u32 s3, 4
    s_cbranch_scc1 E_g0
    s_endpgm
E_g0:
    v_and_b32 v162, 63, v0
    s_mul_i32 s40, s39, 43
    v_add_u32 v163, s40, v162
    s_lshl_b32 s40, s32, 7
    v_add_u32 v161, s40, v163
    v_lshlrev_b32 v161, 12, v161
    v_mov_b32 v164, 0x7f000000
    v_cmp_gt_u32 vcc, 43, v162
    s_nop 1
    v_cndmask_b32 v161, v164, v161, vcc
    v_cmp_gt_u32 vcc, 128, v163
    s_nop 1
    v_cndmask_b32 v161, v164, v161, vcc
    s_mov_b32 s78, 8388608
    s_mov_b32 s79, 0x00020000
    s_cmp_lg_u32 s3, 1
    s_cbranch_scc1 tch_16
    s_cmp_le_u32 s66, 6
    s_cbranch_scc1 tch_16
    s_mul_i32 s40, s26, 13
    s_add_u32 s40, s40, 6
    s_cmp_lt_u32 s40, 32
    s_cselect_b32 s76, s6, s8
    s_cselect_b32 s77, s7, s9
    s_and_b32 s77, s77, 0xffff
    s_and_b32 s40, s40, 31
    s_lshl_b32 s40, s40, 7
    buffer_load_dword v160, v161, s[76:79], s40 offen
tch_16:
    s_cmp_lg_u32 s3, 2
    s_cbranch_scc1 tch_17
    s_cmp_le_u32 s66, 7
    s_cbranch_scc1 tch_17
    s_mul_i32 s40, s26, 13
    s_add_u32 s40, s40, 7
    s_cmp_lt_u32 s40, 32
    s_cselect_b32 s76, s6, s8
    s_cselect_b32 s77, s7, s9
    s_and_b32 s77, s77, 0xffff
    s_and_b32 s40, s40, 31
    s_lshl_b32 s40, s40, 7
    buffer_load_dword v160, v161, s[76:79], s40 offen
tch_17:
    s_cmp_lg_u32 s3, 3
    s_cbranch_scc1 tch_18
    s_cmp_le_u32 s66, 8
    s_cbranch_scc1 tch_18
    s_mul_i32 s40, s26, 13
    s_add_u32 s40, s40, 8
    s_cmp_lt_u32 s40, 32
    s_cselect_b32 s76, s6, s8
    s_cselect_b32 s77, s7, s9
    s_and_b32 s77, s77, 0xffff
    s_and_b32 s40, s40, 31
    s_lshl_b32 s40, s40, 7
    buffer_load_dword v160, v161, s[76:79], s40 offen
tch_18:
    s_cmp_lg_u32 s3, 0
    s_cbranch_scc1 tch_19
    s_cmp_le_u32 s66, 9
    s_cbranch_scc1 tch_19
    s_mul_i32 s40, s26, 13
    s_add_u32 s40, s40, 9
    s_cmp_lt_u32 s40, 32
    s_cselect_b32 s76, s6, s8
    s_cselect_b32 s77, s7, s9
    s_and_b32 s77, s77, 0xffff
    s_and_b32 s40, s40, 31
    s_lshl_b32 s40, s40, 7
    buffer_load_dword v160, v161, s[76:79], s40 offen
tch_19:
    s_cmp_lg_u32 s3, 1
    s_cbranch_scc1 tch_20
    s_cmp_le_u32 s66, 10
    s_cbranch_scc1 tch_20
    s_mul_i32 s40, s26, 13
    s_add_u32 s40, s40, 10
    s_cmp_lt_u32 s40, 32
    s_cselect_b32 s76, s6, s8
    s_cselect_b32 s77, s7, s9
    s_and_b32 s77, s77, 0xffff
    s_and_b32 s40, s40, 31
    s_lshl_b32 s40, s40, 7
    buffer_load_dword v160, v161, s[76:79], s40 offen
tch_20:
    s_cmp_lg_u32 s3, 2
    s_cbranch_scc1 tch_21
    s_cmp_le_u32 s66, 11
    s_cbranch_scc1 tch_21
    s_mul_i32 s40, s26, 13
    s_add_u32 s40, s40, 11
    s_cmp_lt_u32 s40, 32
    s_cselect_b32 s76, s6, s8
    s_cselect_b32 s77, s7, s9
    s_and_b32 s77, s77, 0xffff
    s_and_b32 s40, s40, 31
    s_lshl_b32 s40, s40, 7
    buffer_load_dword v160, v161, s[76:79], s40 offen
tch_21:
    s_cmp_lg_u32 s3, 3
    s_cbranch_scc1 tch_22
    s_cmp_le_u32 s66, 12
    s_cbranch_scc1 tch_22
    s_mul_i32 s40, s26, 13
    s_add_u32 s40, s40, 12
    s_cmp_lt_u32 s40, 32
    s_cselect_b32 s76, s6, s8
    s_cselect_b32 s77, s7, s9
    s_and_b32 s77, s77, 0xffff
    s_and_b32 s40, s40, 31
    s_lshl_b32 s40, s40, 7
    buffer_load_dword v160, v161, s[76:79], s40 offen
tch_22:
    v_mov_b32 v64, 0
    v_mov_b32 v65, 0
    v_mov_b32 v66, 0
    v_mov_b32 v67, 0
    v_mov_b32 v68, 0
    v_mov_b32 v69, 0
    v_mov_b32 v70, 0
    v_mov_b32 v71, 0
    v_mov_b32 v72, 0
    v_mov_b32 v73, 0
    v_mov_b32 v74, 0
    v_mov_b32 v75, 0
    v_mov_b32 v76, 0
    v_mov_b32 v77, 0
    v_mov_b32 v78, 0
    v_mov_b32 v79, 0
    v_mov_b32 v80, 0
    v_mov_b32 v81, 0
    v_mov_b32 v82, 0
    v_mov_b32 v83, 0
    v_mov_b32 v84, 0
    v_mov_b32 v85, 0
    v_mov_b32 v86, 0
    v_mov_b32 v87, 0
    v_mov_b32 v88, 0
    v_mov_b32 v89, 0
    v_mov_b32 v90, 0
    v_mov_b32 v91, 0
    v_mov_b32 v92, 0
    v_mov_b32 v93, 0
    v_mov_b32 v94, 0
    v_mov_b32 v95, 0
    v_mov_b32 v96, 0
    v_mov_b32 v97, 0
    v_mov_b32 v98, 0
    v_mov_b32 v99, 0
    v_mov_b32 v100, 0
    v_mov_b32 v101, 0
    v_mov_b32 v102, 0
    v_mov_b32 v103, 0
    v_mov_b32 v104, 0
    v_mov_b32 v105, 0
    v_mov_b32 v106, 0
    v_mov_b32 v107, 0
    v_mov_b32 v108, 0
    v_mov_b32 v109, 0
    v_mov_b32 v110, 0
    v_mov_b32 v111, 0
    v_mov_b32 v112, 0
    v_mov_b32 v113, 0
    v_mov_b32 v114, 0
    v_mov_b32 v115, 0
    v_mov_b32 v116, 0
    v_mov_b32 v117, 0
    v_mov_b32 v118, 0
    v_mov_b32 v119, 0
    v_mov_b32 v120, 0
    v_mov_b32 v121, 0
    v_mov_b32 v122, 0
    v_mov_b32 v123, 0
    v_mov_b32 v124, 0
    v_mov_b32 v125, 0
    v_mov_b32 v126, 0
    v_mov_b32 v127, 0
    v_mov_b32 v128, 0
    v_mov_b32 v129, 0
    v_mov_b32 v130, 0
    v_mov_b32 v131, 0
    v_mov_b32 v132, 0
    v_mov_b32 v133, 0
    v_mov_b32 v134, 0
    v_mov_b32 v135, 0
    v_mov_b32 v136, 0
    v_mov_b32 v137, 0
    v_mov_b32 v138, 0
    v_mov_b32 v139, 0
    v_mov_b32 v140, 0
    v_mov_b32 v141, 0
    v_mov_b32 v142, 0
    v_mov_b32 v143, 0
    v_mov_b32 v144, 0
    v_mov_b32 v145, 0
    v_mov_b32 v146, 0
    v_mov_b32 v147, 0
    v_mov_b32 v148, 0
    v_mov_b32 v149, 0
    v_mov_b32 v150, 0
    v_mov_b32 v151, 0
    v_mov_b32 v152, 0
    v_mov_b32 v153, 0
    v_mov_b32 v154, 0
    v_mov_b32 v155, 0
    v_mov_b32 v156, 0
    v_mov_b32 v157, 0
    v_mov_b32 v158, 0
    v_mov_b32 v159, 0
    v_and_b32 v60, 15, v0
    v_bfe_u32 v61, v0, 4, 2
    v_lshrrev_b32 v63, 1, v60
    s_lshl_b32 s40, s37, 6
    v_add_u32 v17, s40, v60
    v_lshlrev_b32 v17, 7, v17
    v_add_u32 v18, 0, v61
    v_xor_b32 v18, v18, v63
    v_lshl_add_u32 v1, v18, 4, v17
    v_add_u32 v18, 4, v61
    v_xor_b32 v18, v18, v63
    v_lshl_add_u32 v2, v18, 4, v17
    v_lshrrev_b32 v18, 2, v60
    v_lshl_add_u32 v18, v61, 3, v18
    v_mul_u32_u24 v18, 384, v18
    v_add_u32 v18, 65536, v18
    v_and_b32 v19, 1, v60
    v_lshl_add_u32 v18, v19, 3, v18
    v_lshrrev_b32 v19, 3, v60
    v_lshlrev_b32 v19, 2, v19
    v_and_b32 v62, 1, v61
    v_lshl_or_b32 v19, v62, 1, v19
    v_bfe_u32 v62, v60, 1, 1
    s_mul_i32 s40, s38, 12
    s_add_u32 s41, s40, 0
    v_add_u32 v17, s41, v62
    v_xor_b32 v17, v17, v19
    v_lshl_add_u32 v5, v17, 4, v18
    s_add_u32 s41, s40, 2
    v_add_u32 v17, s41, v62
    v_xor_b32 v17, v17, v19
    v_lshl_add_u32 v6, v17, 4, v18
    s_add_u32 s41, s40, 4
    v_add_u32 v17, s41, v62
    v_xor_b32 v17, v17, v19
    v_lshl_add_u32 v7, v17, 4, v18
    s_add_u32 s41, s40, 6
    v_add_u32 v17, s41, v62
    v_xor_b32 v17, v17, v19
    v_lshl_add_u32 v8, v17, 4, v18
    s_add_u32 s41, s40, 8
    v_add_u32 v17, s41, v62
    v_xor_b32 v17, v17, v19
    v_lshl_add_u32 v9, v17, 4, v18
    s_add_u32 s41, s40, 10
    v_add_u32 v17, s41, v62
    v_xor_b32 v17, v17, v19
    v_lshl_add_u32 v10, v17, 4, v18
E_w2:
    s_barrier
    s_sub_u32 s45, s45, 1
    s_cmp_lg_u32 s45, 0
    s_cbranch_scc1 E_w2
    s_mov_b32 s44, 32768
    s_mov_b32 s45, 49152
    s_mov_b32 s46, 0
    v_add_u32 v3, 32768, v1
    v_add_u32 v4, 32768, v2
    v_add_u32 v11, 49152, v5
    v_add_u32 v12, 49152, v6
    v_add_u32 v13, 49152, v7
    v_add_u32 v14, 49152, v8
    v_add_u32 v15, 49152, v9
    v_add_u32 v16, 49152, v10
    ds_read_b64_tr_b16 v[36:37], v11 offset:0
    ds_read_b64_tr_b16 v[38:39], v11 offset:1536
    ds_read_b64_tr_b16 v[40:41], v12 offset:0
    ds_read_b128 v[20:23], v3 offset:0
    ds_read_b64_tr_b16 v[42:43], v12 offset:1536
    ds_read_b64_tr_b16 v[44:45], v13 offset:0
    ds_read_b64_tr_b16 v[46:47], v13 offset:1536
    ds_read_b128 v[24:27], v3 offset:2048
    ds_read_b128 v[28:31], v3 offset:4096
    ds_read_b128 v[32:35], v3 offset:6144
G2c_loop:
    s_waitcnt lgkmcnt(6)
    v_mfma_f32_16x16x32_bf16 v[64:67], v[36:39], v[20:23], v[64:67]
    ds_read_b64_tr_b16 v[48:49], v14 offset:0
    s_waitcnt lgkmcnt(6)
    v_mfma_f32_16x16x32_bf16 v[68:71], v[40:43], v[20:23], v[68:71]
    ds_read_b64_tr_b16 v[50:51], v14 offset:1536
    s_waitcnt lgkmcnt(5)
    v_mfma_f32_16x16x32_bf16 v[80:83], v[44:47], v[20:23], v[80:83]
    ds_read_b64_tr_b16 v[52:53], v15 offset:0
    s_waitcnt lgkmcnt(5)
    v_mfma_f32_16x16x32_bf16 v[72:75], v[36:39], v[24:27], v[72:75]
    ds_read_b64_tr_b16 v[54:55], v15 offset:1536
    v_mfma_f32_16x16x32_bf16 v[76:79], v[40:43], v[24:27], v[76:79]
    ds_read_b64_tr_b16 v[56:57], v16 offset:0
    v_mfma_f32_16x16x32_bf16 v[88:91], v[44:47], v[24:27], v[88:91]
    ds_read_b64_tr_b16 v[58:59], v16 offset:1536
    s_waitcnt lgkmcnt(7)
    v_mfma_f32_16x16x32_bf16 v[112:115], v[36:39], v[28:31], v[112:115]
    v_mfma_f32_16x16x32_bf16 v[116:119], v[40:43], v[28:31], v[116:119]
    v_mfma_f32_16x16x32_bf16 v[128:131], v[44:47], v[28:31], v[128:131]
    s_waitcnt lgkmcnt(6)
    v_mfma_f32_16x16x32_bf16 v[120:123], v[36:39], v[32:35], v[120:123]
    v_mfma_f32_16x16x32_bf16 v[124:127], v[40:43], v[32:35], v[124:127]
    v_mfma_f32_16x16x32_bf16 v[136:139], v[44:47], v[32:35], v[136:139]
    s_waitcnt lgkmcnt(4)
    v_mfma_f32_16x16x32_bf16 v[84:87], v[48:51], v[20:23], v[84:87]
    ds_read_b64_tr_b16 v[36:37], v11 offset:12288
    s_waitcnt lgkmcnt(3)
    v_mfma_f32_16x16x32_bf16 v[96:99], v[52:55], v[20:23], v[96:99]
    ds_read_b64_tr_b16 v[38:39], v11 offset:13824
    s_waitcnt lgkmcnt(2)
    v_mfma_f32_16x16x32_bf16 v[100:103], v[56:59], v[20:23], v[100:103]
    ds_read_b64_tr_b16 v[40:41], v12 offset:12288
    ds_read_b128 v[20:23], v4 offset:0
    v_mfma_f32_16x16x32_bf16 v[92:95], v[48:51], v[24:27], v[92:95]
    ds_read_b64_tr_b16 v[42:43], v12 offset:13824
    v_mfma_f32_16x16x32_bf16 v[104:107], v[52:55], v[24:27], v[104:107]
    ds_read_b64_tr_b16 v[44:45], v13 offset:12288
    v_mfma_f32_16x16x32_bf16 v[108:111], v[56:59], v[24:27], v[108:111]
    ds_read_b64_tr_b16 v[46:47], v13 offset:13824
    ds_read_b128 v[24:27], v4 offset:2048
    v_mfma_f32_16x16x32_bf16 v[132:135], v[48:51], v[28:31], v[132:135]
    v_mfma_f32_16x16x32_bf16 v[144:147], v[52:55], v[28:31], v[144:147]
    v_mfma_f32_16x16x32_bf16 v[148:151], v[56:59], v[28:31], v[148:151]
    ds_read_b128 v[28:31], v4 offset:4096
    v_mfma_f32_16x16x32_bf16 v[140:143], v[48:51], v[32:35], v[140:143]
    v_mfma_f32_16x16x32_bf16 v[152:155], v[52:55], v[32:35], v[152:155]
    v_mfma_f32_16x16x32_bf16 v[156:159], v[56:59], v[32:35], v[156:159]
    ds_read_b128 v[32:35], v4 offset:6144
    s_waitcnt lgkmcnt(6)
    v_mfma_f32_16x16x32_bf16 v[64:67], v[36:39], v[20:23], v[64:67]
    ds_read_b64_tr_b16 v[48:49], v14 offset:12288
    s_waitcnt lgkmcnt(6)
    v_mfma_f32_16x16x32_bf16 v[68:71], v[40:43], v[20:23], v[68:71]
    ds_read_b64_tr_b16 v[50:51], v14 offset:13824
    s_waitcnt lgkmcnt(5)
    v_mfma_f32_16x16x32_bf16 v[80:83], v[44:47], v[20:23], v[80:83]
    ds_read_b64_tr_b16 v[52:53], v15 offset:12288
    s_waitcnt lgkmcnt(5)
    v_mfma_f32_16x16x32_bf16 v[72:75], v[36:39], v[24:27], v[72:75]
    ds_read_b64_tr_b16 v[54:55], v15 offset:13824
    v_mfma_f32_16x16x32_bf16 v[76:79], v[40:43], v[24:27], v[76:79]
    ds_read_b64_tr_b16 v[56:57], v16 offset:12288
    v_mfma_f32_16x16x32_bf16 v[88:91], v[44:47], v[24:27], v[88:91]
    ds_read_b64_tr_b16 v[58:59], v16 offset:13824
    s_waitcnt lgkmcnt(7)
    v_mfma_f32_16x16x32_bf16 v[112:115], v[36:39], v[28:31], v[112:115]
    v_mfma_f32_16x16x32_bf16 v[116:119], v[40:43], v[28:31], v[116:119]
    v_mfma_f32_16x16x32_bf16 v[128:131], v[44:47], v[28:31], v[128:131]
    s_waitcnt lgkmcnt(6)
    v_mfma_f32_16x16x32_bf16 v[120:123], v[36:39], v[32:35], v[120:123]
    v_mfma_f32_16x16x32_bf16 v[124:127], v[40:43], v[32:35], v[124:127]
    v_mfma_f32_16x16x32_bf16 v[136:139], v[44:47], v[32:35], v[136:139]
    s_add_u32 s44, s44, 16384
    s_add_u32 s45, s45, 24576
    s_cmp_ge_u32 s44, 65536
    s_cselect_b32 s44, 0, s44
    s_cselect_b32 s45, 0, s45
    s_waitcnt lgkmcnt(0)
    v_add_u32 v3, s44, v1
    v_add_u32 v4, s44, v2
    v_add_u32 v11, s45, v5
    v_add_u32 v12, s45, v6
    v_add_u32 v13, s45, v7
    v_add_u32 v14, s45, v8
    v_add_u32 v15, s45, v9
    v_add_u32 v16, s45, v10
    s_cmp_lg_u32 s46, 3
    s_cbranch_scc1 G2c_nb
    s_waitcnt vmcnt(0)
    s_barrier
    s_cmp_lg_u32 s3, 0
    s_cbranch_scc1 G2c_ab
    s_cmp_eq_u32 s90, -1
    s_cbranch_scc1 G2c_ab
    v_mov_b32 v60, s14
    v_mov_b32 v61, s15
    v_mov_b32 v63, 0
    s_mov_b64 exec, 1
    buffer_store_dwordx2 v[60:61], v63, s[92:95], s90 offen sc1
    s_mov_b64 exec, -1
    s_branch G2c_ab
G2c_nb:
    s_barrier
G2c_ab:
    v_mfma_f32_16x16x32_bf16 v[84:87], v[48:51], v[20:23], v[84:87]
    ds_read_b64_tr_b16 v[36:37], v11 offset:0
    v_mfma_f32_16x16x32_bf16 v[96:99], v[52:55], v[20:23], v[96:99]
    ds_read_b64_tr_b16 v[38:39], v11 offset:1536
    v_mfma_f32_16x16x32_bf16 v[100:103], v[56:59], v[20:23], v[100:103]
    ds_read_b64_tr_b16 v[40:41], v12 offset:0
    ds_read_b128 v[20:23], v3 offset:0
    v_mfma_f32_16x16x32_bf16 v[92:95], v[48:51], v[24:27], v[92:95]
    ds_read_b64_tr_b16 v[42:43], v12 offset:1536
    v_mfma_f32_16x16x32_bf16 v[104:107], v[52:55], v[24:27], v[104:107]
    ds_read_b64_tr_b16 v[44:45], v13 offset:0
    v_mfma_f32_16x16x32_bf16 v[108:111], v[56:59], v[24:27], v[108:111]
    ds_read_b64_tr_b16 v[46:47], v13 offset:1536
    ds_read_b128 v[24:27], v3 offset:2048
    v_mfma_f32_16x16x32_bf16 v[132:135], v[48:51], v[28:31], v[132:135]
    v_mfma_f32_16x16x32_bf16 v[144:147], v[52:55], v[28:31], v[144:147]
    v_mfma_f32_16x16x32_bf16 v[148:151], v[56:59], v[28:31], v[148:151]
    ds_read_b128 v[28:31], v3 offset:4096
    v_mfma_f32_16x16x32_bf16 v[140:143], v[48:51], v[32:35], v[140:143]
    v_mfma_f32_16x16x32_bf16 v[152:155], v[52:55], v[32:35], v[152:155]
    v_mfma_f32_16x16x32_bf16 v[156:159], v[56:59], v[32:35], v[156:159]
    ds_read_b128 v[32:35], v3 offset:6144
    s_add_u32 s46, s46, 1
    s_cmp_lt_u32 s46, s67
    s_cbranch_scc1 G2c_loop
    s_waitcnt lgkmcnt(0)
    s_nop 15
    s_add_u32 s68, s24, 41943040
    s_addc_u32 s69, s25, 0
    s_and_b32 s69, s69, 0xffff
    s_mov_b32 s70, 11796480
    s_mov_b32 s71, 0x00020000
    s_mul_i32 s42, s33, 49152
    s_mul_i32 s41, s3, 12288
    s_add_u32 s42, s42, s41
    v_and_b32 v7, 63, v0
    v_lshlrev_b32 v7, 4, v7
    s_add_u32 s43, s3, 5
    s_sub_u32 s43, s43, s26
    s_add_u32 s40, s43, 0
    s_cmp_eq_u32 s40, 5
    s_cbranch_scc1 pst_23
    s_cmp_eq_u32 s40, 10
    s_cbranch_scc1 pst_23
    s_add_u32 s41, s42, 0
    v_cvt_pk_bf16_f32 v20, v64, v65
    v_cvt_pk_bf16_f32 v21, v66, v67
    v_cvt_pk_bf16_f32 v22, v68, v69
    v_cvt_pk_bf16_f32 v23, v70, v71
    v_cvt_pk_bf16_f32 v24, v72, v73
    v_cvt_pk_bf16_f32 v25, v74, v75
    v_cvt_pk_bf16_f32 v26, v76, v77
    v_cvt_pk_bf16_f32 v27, v78, v79
    buffer_store_dwordx4 v[20:23], v7, s[68:71], s41 offen sc1
    buffer_store_dwordx4 v[24:27], v7, s[68:71], s41 offen offset:1024 sc1
pst_23:
    s_add_u32 s40, s43, 1
    s_cmp_eq_u32 s40, 5
    s_cbranch_scc1 pst_24
    s_cmp_eq_u32 s40, 10
    s_cbranch_scc1 pst_24
    s_add_u32 s41, s42, 2048
    v_cvt_pk_bf16_f32 v28, v80, v81
    v_cvt_pk_bf16_f32 v29, v82, v83
    v_cvt_pk_bf16_f32 v30, v84, v85
    v_cvt_pk_bf16_f32 v31, v86, v87
    v_cvt_pk_bf16_f32 v32, v88, v89
    v_cvt_pk_bf16_f32 v33, v90, v91
    v_cvt_pk_bf16_f32 v34, v92, v93
    v_cvt_pk_bf16_f32 v35, v94, v95
    buffer_store_dwordx4 v[28:31], v7, s[68:71], s41 offen sc1
    buffer_store_dwordx4 v[32:35], v7, s[68:71], s41 offen offset:1024 sc1
pst_24:
    s_add_u32 s40, s43, 2
    s_cmp_eq_u32 s40, 5
    s_cbranch_scc1 pst_25
    s_cmp_eq_u32 s40, 10
    s_cbranch_scc1 pst_25
    s_add_u32 s41, s42, 4096
    v_cvt_pk_bf16_f32 v20, v96, v97
    v_cvt_pk_bf16_f32 v21, v98, v99
    v_cvt_pk_bf16_f32 v22, v100, v101
    v_cvt_pk_bf16_f32 v23, v102, v103
    v_cvt_pk_bf16_f32 v24, v104, v105
    v_cvt_pk_bf16_f32 v25, v106, v107
    v_cvt_pk_bf16_f32 v26, v108, v109
    v_cvt_pk_bf16_f32 v27, v110, v111
    buffer_store_dwordx4 v[20:23], v7, s[68:71], s41 offen sc1
    buffer_store_dwordx4 v[24:27], v7, s[68:71], s41 offen offset:1024 sc1
pst_25:
    s_add_u32 s40, s43, 3
    s_cmp_eq_u32 s40, 5
    s_cbranch_scc1 pst_26
    s_cmp_eq_u32 s40, 10
    s_cbranch_scc1 pst_26
    s_add_u32 s41, s42, 6144
    v_cvt_pk_bf16_f32 v28, v112, v113
    v_cvt_pk_bf16_f32 v29, v114, v115
    v_cvt_pk_bf16_f32 v30, v116, v117
    v_cvt_pk_bf16_f32 v31, v118, v119
    v_cvt_pk_bf16_f32 v32, v120, v121
    v_cvt_pk_bf16_f32 v33, v122, v123
    v_cvt_pk_bf16_f32 v34, v124, v125
    v_cvt_pk_bf16_f32 v35, v126, v127
    buffer_store_dwordx4 v[28:31], v7, s[68:71], s41 offen sc1
    buffer_store_dwordx4 v[32:35], v7, s[68:71], s41 offen offset:1024 sc1
pst_26:
    s_add_u32 s40, s43, 4
    s_cmp_eq_u32 s40, 5
    s_cbranch_scc1 pst_27
    s_cmp_eq_u32 s40, 10
    s_cbranch_scc1 pst_27
    s_add_u32 s41, s42, 8192
    v_cvt_pk_bf16_f32 v20, v128, v129
    v_cvt_pk_bf16_f32 v21, v130, v131
    v_cvt_pk_bf16_f32 v22, v132, v133
    v_cvt_pk_bf16_f32 v23, v134, v135
    v_cvt_pk_bf16_f32 v24, v136, v137
    v_cvt_pk_bf16_f32 v25, v138, v139
    v_cvt_pk_bf16_f32 v26, v140, v141
    v_cvt_pk_bf16_f32 v27, v142, v143
    buffer_store_dwordx4 v[20:23], v7, s[68:71], s41 offen sc1
    buffer_store_dwordx4 v[24:27], v7, s[68:71], s41 offen offset:1024 sc1
pst_27:
    s_add_u32 s40, s43, 5
    s_cmp_eq_u32 s40, 5
    s_cbranch_scc1 pst_28
    s_cmp_eq_u32 s40, 10
    s_cbranch_scc1 pst_28
    s_add_u32 s41, s42, 10240
    v_cvt_pk_bf16_f32 v28, v144, v145
    v_cvt_pk_bf16_f32 v29, v146, v147
    v_cvt_pk_bf16_f32 v30, v148, v149
    v_cvt_pk_bf16_f32 v31, v150, v151
    v_cvt_pk_bf16_f32 v32, v152, v153
    v_cvt_pk_bf16_f32 v33, v154, v155
    v_cvt_pk_bf16_f32 v34, v156, v157
    v_cvt_pk_bf16_f32 v35, v158, v159
    buffer_store_dwordx4 v[28:31], v7, s[68:71], s41 offen sc1
    buffer_store_dwordx4 v[32:35], v7, s[68:71], s41 offen offset:1024 sc1
pst_28:
    s_waitcnt vmcnt(0)
    s_barrier
    s_lshl_b32 s41, s27, 8
    s_add_u32 s41, s41, 8192
    s_lshl_b32 s47, s26, 3
    s_add_u32 s47, s47, s41
    s_cmp_lg_u32 s3, 0
    s_cbranch_scc1 K_psig
    v_mov_b32 v60, s14
    v_mov_b32 v61, s15
    v_mov_b32 v63, 0
    s_mov_b64 exec, 1
    buffer_store_dwordx2 v[60:61], v63, s[92:95], s47 offen sc1
    s_mov_b64 exec, -1
    s_branch K_psig2
K_psig:
    v_mov_b32 v63, 0
    s_mov_b32 s101, 0
nonce_29:
    s_add_u32 s101, s101, 1
    s_cmp_ge_u32 s101, 0x40000
    s_cbranch_scc1 nonced_30
    buffer_load_dwordx2 v[60:61], v63, s[28:31], 0 offen sc1
    s_waitcnt vmcnt(0)
    v_readfirstlane_b32 s14, v60
    v_readfirstlane_b32 s15, v61
    s_or_b32 s40, s14, s15
    s_cmp_lg_u32 s40, 0
    s_cbranch_scc1 nonced_30
    s_sleep 2
    s_branch nonce_29
nonced_30:
K_psig2:
    s_mov_b32 s72, s4
    s_and_b32 s73, s5, 0xffff
    s_mov_b32 s74, 2359296
    s_mov_b32 s75, 0x00020000
    s_mov_b32 s76, s20
    s_and_b32 s77, s21, 0xffff
    s_mov_b32 s78, 2359296
    s_mov_b32 s79, 0x00020000
    s_lshl_b32 s49, s32, 7
    s_lshl_b32 s40, s37, 6
    s_add_u32 s49, s49, s40
    s_mul_i32 s48, s39, 384
    s_mul_i32 s40, s38, 192
    s_add_u32 s48, s48, s40
    v_and_b32 v3, 15, v0
    v_bfe_u32 v4, v0, 4, 2
    v_add_u32 v3, s49, v3
    v_mul_u32_u24 v3, 1152, v3
    v_add_u32 v3, s48, v3
    v_lshl_add_u32 v5, v4, 3, v3
    v_bfe_u32 v2, v0, 4, 1
    v_lshl_add_u32 v6, v2, 5, v3
    v_bfe_u32 v2, v0, 5, 1
    v_lshl_add_u32 v6, v2, 4, v6
    s_mul_i32 s42, s27, 49152
    s_mul_i32 s40, s3, 12288
    s_add_u32 s42, s42, s40
    s_mov_b32 s46, 5
    v_and_b32 v63, 31, v0
    v_lshlrev_b32 v63, 3, v63
    s_mov_b32 s101, 0
poll_31:
    s_add_u32 s101, s101, 1
    s_cmp_ge_u32 s101, 0x40000
    s_cbranch_scc1 polld_32
    buffer_load_dwordx2 v[60:61], v63, s[92:95], s41 offen sc1
    s_waitcnt vmcnt(0)
    v_cmp_eq_u32 s[62:63], s14, v60
    v_cmp_eq_u32 vcc, s15, v61
    s_nop 1
    s_and_b32 s40, s62, vcc_lo
    s_and_b32 s40, s40, 31
    s_cmp_eq_u32 s40, 31
    s_cbranch_scc1 polld_32
    s_sleep 4
    s_branch poll_31
polld_32:
F_loop:
    s_sub_i32 s45, s46, s43
    s_cmp_lt_i32 s45, 0
    s_cbranch_scc1 F_next
    s_cmp_gt_i32 s45, 5
    s_cbranch_scc1 F_next
    s_cmp_ge_u32 s45, 3
    s_cselect_b32 s40, 3, 0
    s_cselect_b32 s47, 36864, 0
    s_sub_u32 s40, s45, s40
    s_lshl_b32 s40, s40, 6
    s_add_u32 s47, s47, s40
    s_mul_i32 s48, s45, 2048
    s_add_u32 s48, s48, s42
    s_add_u32 s49, s47, 18432
    buffer_load_dwordx2 v[160:161], v5, s[72:75], s47 offen offset:0
    buffer_load_dwordx2 v[162:163], v5, s[72:75], s47 offen offset:32
    buffer_load_dwordx2 v[164:165], v5, s[72:75], s49 offen offset:0
    buffer_load_dwordx2 v[166:167], v5, s[72:75], s49 offen offset:32
    s_add_u32 s44, s26, 1
    s_sub_u32 s40, s44, 5
    s_cmp_ge_u32 s44, 5
    s_cselect_b32 s44, s40, s44
    s_mul_i32 s44, s44, 2359296
    s_add_u32 s44, s44, s48
    buffer_load_dwordx4 v[8:11], v7, s[68:71], s44 offen sc1
    buffer_load_dwordx4 v[12:15], v7, s[68:71], s44 offen offset:1024 sc1
    s_add_u32 s44, s26, 2
    s_sub_u32 s40, s44, 5
    s_cmp_ge_u32 s44, 5
    s_cselect_b32 s44, s40, s44
    s_mul_i32 s44, s44, 2359296
    s_add_u32 s44, s44, s48
    buffer_load_dwordx4 v[16:19], v7, s[68:71], s44 offen sc1
    buffer_load_dwordx4 v[20:23], v7, s[68:71], s44 offen offset:1024 sc1
    s_add_u32 s44, s26, 3
    s_sub_u32 s40, s44, 5
    s_cmp_ge_u32 s44, 5
    s_cselect_b32 s44, s40, s44
    s_mul_i32 s44, s44, 2359296
    s_add_u32 s44, s44, s48
    buffer_load_dwordx4 v[24:27], v7, s[68:71], s44 offen sc1
    buffer_load_dwordx4 v[28:31], v7, s[68:71], s44 offen offset:1024 sc1
    s_add_u32 s44, s26, 4
    s_sub_u32 s40, s44, 5
    s_cmp_ge_u32 s44, 5
    s_cselect_b32 s44, s40, s44
    s_mul_i32 s44, s44, 2359296
    s_add_u32 s44, s44, s48
    buffer_load_dwordx4 v[32:35], v7, s[68:71], s44 offen sc1
    buffer_load_dwordx4 v[36:39], v7, s[68:71], s44 offen offset:1024 sc1
    s_cmp_lg_u32 s45, 0
    s_cbranch_scc1 F_m0
    v_mov_b32 v40, v64
    v_mov_b32 v41, v65
    v_mov_b32 v42, v66
    v_mov_b32 v43, v67
    v_mov_b32 v44, v68
    v_mov_b32 v45, v69
    v_mov_b32 v46, v70
    v_mov_b32 v47, v71
    v_mov_b32 v48, v72
    v_mov_b32 v49, v73
    v_mov_b32 v50, v74
    v_mov_b32 v51, v75
    v_mov_b32 v52, v76
    v_mov_b32 v53, v77
    v_mov_b32 v54, v78
    v_mov_b32 v55, v79
F_m0:
    s_cmp_lg_u32 s45, 1
    s_cbranch_scc1 F_m1
    v_mov_b32 v40, v80
    v_mov_b32 v41, v81
    v_mov_b32 v42, v82
    v_mov_b32 v43, v83
    v_mov_b32 v44, v84
    v_mov_b32 v45, v85
    v_mov_b32 v46, v86
    v_mov_b32 v47, v87
    v_mov_b32 v48, v88
    v_mov_b32 v49, v89
    v_mov_b32 v50, v90
    v_mov_b32 v51, v91
    v_mov_b32 v52, v92
    v_mov_b32 v53, v93
    v_mov_b32 v54, v94
    v_mov_b32 v55, v95
F_m1:
    s_cmp_lg_u32 s45, 2
    s_cbranch_scc1 F_m2
    v_mov_b32 v40, v96
    v_mov_b32 v41, v97
    v_mov_b32 v42, v98
    v_mov_b32 v43, v99
    v_mov_b32 v44, v100
    v_mov_b32 v45, v101
    v_mov_b32 v46, v102
    v_mov_b32 v47, v103
    v_mov_b32 v48, v104
    v_mov_b32 v49, v105
    v_mov_b32 v50, v106
    v_mov_b32 v51, v107
    v_mov_b32 v52, v108
    v_mov_b32 v53, v109
    v_mov_b32 v54, v110
    v_mov_b32 v55, v111
F_m2:
    s_cmp_lg_u32 s45, 3
    s_cbranch_scc1 F_m3
    v_mov_b32 v40, v112
    v_mov_b32 v41, v113
    v_mov_b32 v42, v114
    v_mov_b32 v43, v115
    v_mov_b32 v44, v116
    v_mov_b32 v45, v117
    v_mov_b32 v46, v118
    v_mov_b32 v47, v119
    v_mov_b32 v48, v120
    v_mov_b32 v49, v121
    v_mov_b32 v50, v122
    v_mov_b32 v51, v123
    v_mov_b32 v52, v124
    v_mov_b32 v53, v125
    v_mov_b32 v54, v126
    v_mov_b32 v55, v127
F_m3:
    s_cmp_lg_u32 s45, 4
    s_cbranch_scc1 F_m4
    v_mov_b32 v40, v128
    v_mov_b32 v41, v129
    v_mov_b32 v42, v130
    v_mov_b32 v43, v131
    v_mov_b32 v44, v132
    v_mov_b32 v45, v133
    v_mov_b32 v46, v134
    v_mov_b32 v47, v135
    v_mov_b32 v48, v136
    v_mov_b32 v49, v137
    v_mov_b32 v50, v138
    v_mov_b32 v51, v139
    v_mov_b32 v52, v140
    v_mov_b32 v53, v141
    v_mov_b32 v54, v142
    v_mov_b32 v55, v143
F_m4:
    s_cmp_lg_u32 s45, 5
    s_cbranch_scc1 F_m5
    v_mov_b32 v40, v144
    v_mov_b32 v41, v145
    v_mov_b32 v42, v146
    v_mov_b32 v43, v147
    v_mov_b32 v44, v148
    v_mov_b32 v45, v149
    v_mov_b32 v46, v150
    v_mov_b32 v47, v151
    v_mov_b32 v48, v152
    v_mov_b32 v49, v153
    v_mov_b32 v50, v154
    v_mov_b32 v51, v155
    v_mov_b32 v52, v156
    v_mov_b32 v53, v157
    v_mov_b32 v54, v158
    v_mov_b32 v55, v159
F_m5:
    s_waitcnt vmcnt(6)
    v_lshlrev_b32 v56, 16, v8
    v_and_b32 v57, 0xffff0000, v8
    v_add_f32 v40, v40, v56
    v_add_f32 v41, v41, v57
    v_lshlrev_b32 v56, 16, v9
    v_and_b32 v57, 0xffff0000, v9
    v_add_f32 v42, v42, v56
    v_add_f32 v43, v43, v57
    v_lshlrev_b32 v56, 16, v10
    v_and_b32 v57, 0xffff0000, v10
    v_add_f32 v44, v44, v56
    v_add_f32 v45, v45, v57
    v_lshlrev_b32 v56, 16, v11
    v_and_b32 v57, 0xffff0000, v11
    v_add_f32 v46, v46, v56
    v_add_f32 v47, v47, v57
    v_lshlrev_b32 v56, 16, v12
    v_and_b32 v57, 0xffff0000, v12
    v_add_f32 v48, v48, v56
    v_add_f32 v49, v49, v57
    v_lshlrev_b32 v56, 16, v13
    v_and_b32 v57, 0xffff0000, v13
    v_add_f32 v50, v50, v56
    v_add_f32 v51, v51, v57
    v_lshlrev_b32 v56, 16, v14
    v_and_b32 v57, 0xffff0000, v14
    v_add_f32 v52, v52, v56
    v_add_f32 v53, v53, v57
    v_lshlrev_b32 v56, 16, v15
    v_and_b32 v57, 0xffff0000, v15
    v_add_f32 v54, v54, v56
    v_add_f32 v55, v55, v57
    s_waitcnt vmcnt(4)
    v_lshlrev_b32 v56, 16, v16
    v_and_b32 v57, 0xffff0000, v16
    v_add_f32 v40, v40, v56
    v_add_f32 v41, v41, v57
    v_lshlrev_b32 v56, 16, v17
    v_and_b32 v57, 0xffff0000, v17
    v_add_f32 v42, v42, v56
    v_add_f32 v43, v43, v57
    v_lshlrev_b32 v56, 16, v18
    v_and_b32 v57, 0xffff0000, v18
    v_add_f32 v44, v44, v56
    v_add_f32 v45, v45, v57
    v_lshlrev_b32 v56, 16, v19
    v_and_b32 v57, 0xffff0000, v19
    v_add_f32 v46, v46, v56
    v_add_f32 v47, v47, v57
    v_lshlrev_b32 v56, 16, v20
    v_and_b32 v57, 0xffff0000, v20
    v_add_f32 v48, v48, v56
    v_add_f32 v49, v49, v57
    v_lshlrev_b32 v56, 16, v21
    v_and_b32 v57, 0xffff0000, v21
    v_add_f32 v50, v50, v56
    v_add_f32 v51, v51, v57
    v_lshlrev_b32 v56, 16, v22
    v_and_b32 v57, 0xffff0000, v22
    v_add_f32 v52, v52, v56
    v_add_f32 v53, v53, v57
    v_lshlrev_b32 v56, 16, v23
    v_and_b32 v57, 0xffff0000, v23
    v_add_f32 v54, v54, v56
    v_add_f32 v55, v55, v57
    s_waitcnt vmcnt(2)
    v_lshlrev_b32 v56, 16, v24
    v_and_b32 v57, 0xffff0000, v24
    v_add_f32 v40, v40, v56
    v_add_f32 v41, v41, v57
    v_lshlrev_b32 v56, 16, v25
    v_and_b32 v57, 0xffff0000, v25
    v_add_f32 v42, v42, v56
    v_add_f32 v43, v43, v57
    v_lshlrev_b32 v56, 16, v26
    v_and_b32 v57, 0xffff0000, v26
    v_add_f32 v44, v44, v56
    v_add_f32 v45, v45, v57
    v_lshlrev_b32 v56, 16, v27
    v_and_b32 v57, 0xffff0000, v27
    v_add_f32 v46, v46, v56
    v_add_f32 v47, v47, v57
    v_lshlrev_b32 v56, 16, v28
    v_and_b32 v57, 0xffff0000, v28
    v_add_f32 v48, v48, v56
    v_add_f32 v49, v49, v57
    v_lshlrev_b32 v56, 16, v29
    v_and_b32 v57, 0xffff0000, v29
    v_add_f32 v50, v50, v56
    v_add_f32 v51, v51, v57
    v_lshlrev_b32 v56, 16, v30
    v_and_b32 v57, 0xffff0000, v30
    v_add_f32 v52, v52, v56
    v_add_f32 v53, v53, v57
    v_lshlrev_b32 v56, 16, v31
    v_and_b32 v57, 0xffff0000, v31
    v_add_f32 v54, v54, v56
    v_add_f32 v55, v55, v57
    s_waitcnt vmcnt(0)
    v_lshlrev_b32 v56, 16, v32
    v_and_b32 v57, 0xffff0000, v32
    v_add_f32 v40, v40, v56
    v_add_f32 v41, v41, v57
    v_lshlrev_b32 v56, 16, v33
    v_and_b32 v57, 0xffff0000, v33
    v_add_f32 v42, v42, v56
    v_add_f32 v43, v43, v57
    v_lshlrev_b32 v56, 16, v34
    v_and_b32 v57, 0xffff0000, v34
    v_add_f32 v44, v44, v56
    v_add_f32 v45, v45, v57
    v_lshlrev_b32 v56, 16, v35
    v_and_b32 v57, 0xffff0000, v35
    v_add_f32 v46, v46, v56
    v_add_f32 v47, v47, v57
    v_lshlrev_b32 v56, 16, v36
    v_and_b32 v57, 0xffff0000, v36
    v_add_f32 v48, v48, v56
    v_add_f32 v49, v49, v57
    v_lshlrev_b32 v56, 16, v37
    v_and_b32 v57, 0xffff0000, v37
    v_add_f32 v50, v50, v56
    v_add_f32 v51, v51, v57
    v_lshlrev_b32 v56, 16, v38
    v_and_b32 v57, 0xffff0000, v38
    v_add_f32 v52, v52, v56
    v_add_f32 v53, v53, v57
    v_lshlrev_b32 v56, 16, v39
    v_and_b32 v57, 0xffff0000, v39
    v_add_f32 v54, v54, v56
    v_add_f32 v55, v55, v57
    v_lshlrev_b32 v56, 16, v160
    v_and_b32 v57, 0xffff0000, v160
    v_lshlrev_b32 v58, 16, v161
    v_and_b32 v59, 0xffff0000, v161
    v_add_f32 v40, v40, v56
    v_add_f32 v41, v41, v57
    v_add_f32 v42, v42, v58
    v_add_f32 v43, v43, v59
    v_cvt_pk_bf16_f32 v8, v40, v41
    v_cvt_pk_bf16_f32 v9, v42, v43
    v_lshlrev_b32 v56, 16, v162
    v_and_b32 v57, 0xffff0000, v162
    v_lshlrev_b32 v58, 16, v163
    v_and_b32 v59, 0xffff0000, v163
    v_add_f32 v44, v44, v56
    v_add_f32 v45, v45, v57
    v_add_f32 v46, v46, v58
    v_add_f32 v47, v47, v59
    v_cvt_pk_bf16_f32 v10, v44, v45
    v_cvt_pk_bf16_f32 v11, v46, v47
    v_lshlrev_b32 v56, 16, v164
    v_and_b32 v57, 0xffff0000, v164
    v_lshlrev_b32 v58, 16, v165
    v_and_b32 v59, 0xffff0000, v165
    v_add_f32 v48, v48, v56
    v_add_f32 v49, v49, v57
    v_add_f32 v50, v50, v58
    v_add_f32 v51, v51, v59
    v_cvt_pk_bf16_f32 v12, v48, v49
    v_cvt_pk_bf16_f32 v13, v50, v51
    v_lshlrev_b32 v56, 16, v166
    v_and_b32 v57, 0xffff0000, v166
    v_lshlrev_b32 v58, 16, v167
    v_and_b32 v59, 0xffff0000, v167
    v_add_f32 v52, v52, v56
    v_add_f32 v53, v53, v57
    v_add_f32 v54, v54, v58
    v_add_f32 v55, v55, v59
    v_cvt_pk_bf16_f32 v14, v52, v53
    v_cvt_pk_bf16_f32 v15, v54, v55
    s_nop 1
    v_permlane16_swap_b32 v8, v10
    v_permlane16_swap_b32 v9, v11
    v_permlane16_swap_b32 v12, v14
    v_permlane16_swap_b32 v13, v15
    buffer_store_dwordx4 v[8:11], v6, s[76:79], s47 offen
    buffer_store_dwordx4 v[12:15], v6, s[76:79], s49 offen
    s_nop 1
F_next:
    s_add_u32 s46, s46, 5
    s_cmp_le_u32 s46, 10
    s_cbranch_scc1 F_loop
    s_endpgm
K_loader:
    s_cmp_ge_u32 s3, 10
    s_cbranch_scc1 K_loadB
    s_add_u32 s72, s24, 0
    s_addc_u32 s73, s25, 0
    s_and_b32 s73, s73, 0xffff
    s_mov_b32 s74, 2359296
    s_mov_b32 s75, 0x00020000
    v_and_b32 v60, 63, v0
    v_lshrrev_b32 v61, 3, v60
    v_mul_u32_u24 v61, 1152, v61
    v_and_b32 v62, 7, v60
    v_lshrrev_b32 v63, 4, v60
    v_xor_b32 v62, v62, v63
    v_lshl_add_u32 v1, v62, 4, v61
    v_xor_b32 v62, 4, v62
    v_lshl_add_u32 v2, v62, 4, v61
    v_and_b32 v60, 63, v0
    v_lshrrev_b32 v61, 3, v60
    v_mul_u32_u24 v61, 4096, v61
    v_and_b32 v62, 7, v60
    v_lshrrev_b32 v63, 4, v60
    v_xor_b32 v62, v62, v63
    v_lshl_add_u32 v3, v62, 4, v61
    v_xor_b32 v62, 4, v62
    v_lshl_add_u32 v4, v62, 4, v61
    s_sub_u32 s59, s3, 8
    s_lshl_b32 s41, s64, 7
    s_lshl_b32 s56, s59, 6
    s_add_u32 s41, s41, s56
    s_mul_i32 s55, s41, 1152
    s_lshl_b32 s41, s32, 7
    s_add_u32 s41, s41, s56
    s_lshl_b32 s49, s41, 12
    s_lshl_b32 s56, s59, 13
    s_add_u32 s60, s24, 16777216
    s_addc_u32 s61, s25, 0
    s_mov_b32 s70, 8388608
    s_mov_b32 s71, 0x00020000
    s_barrier
    s_lshr_b32 s41, s64, 1
    s_lshl_b32 s41, s41, 8
    s_add_u32 s41, s41, 0
    v_mov_b32 v63, 0
    s_mov_b32 s101, 0
nonce_33:
    s_add_u32 s101, s101, 1
    s_cmp_ge_u32 s101, 0x40000
    s_cbranch_scc1 nonced_34
    buffer_load_dwordx2 v[60:61], v63, s[28:31], 0 offen sc1
    s_waitcnt vmcnt(0)
    v_readfirstlane_b32 s14, v60
    v_readfirstlane_b32 s15, v61
    s_or_b32 s40, s14, s15
    s_cmp_lg_u32 s40, 0
    s_cbranch_scc1 nonced_34
    s_sleep 2
    s_branch nonce_33
nonced_34:
    v_and_b32 v63, 31, v0
    v_lshlrev_b32 v63, 3, v63
    s_mov_b32 s101, 0
poll_35:
    s_add_u32 s101, s101, 1
    s_cmp_ge_u32 s101, 0x40000
    s_cbranch_scc1 polld_36
    buffer_load_dwordx2 v[60:61], v63, s[92:95], s41 offen sc1
    s_waitcnt vmcnt(0)
    v_cmp_eq_u32 s[62:63], s14, v60
    v_cmp_eq_u32 vcc, s15, v61
    s_nop 1
    s_and_b32 s40, s62, vcc_lo
    s_and_b32 s40, s40, 1073741823
    s_cmp_eq_u32 s40, 1073741823
    s_cbranch_scc1 polld_36
    s_sleep 4
    s_branch poll_35
polld_36:
    s_mov_b32 s48, 0x3
    s_cmp_eq_u32 s26, 1
    s_cselect_b32 s48, 0xe, s48
    s_cmp_eq_u32 s26, 2
    s_cselect_b32 s48, 0x18, s48
    s_cmp_eq_u32 s26, 3
    s_cselect_b32 s48, 0x60, s48
    s_cmp_eq_u32 s26, 4
    s_cselect_b32 s48, 0x180, s48
    s_mul_i32 s46, s26, 3
    s_lshl_b32 s46, 0xe00, s46
    s_lshl_b32 s47, s32, 8
    s_add_u32 s47, s47, 4096
    s_mov_b32 s50, 0
    s_mov_b32 s51, 0
    s_mov_b32 s52, -4
LA_loop:
    s_cmp_lt_i32 s52, -1
    s_cbranch_scc1 LA_iss0
    s_sub_i32 s53, s50, s52
    s_cmp_ge_i32 s53, 4
    s_cbranch_scc1 LA_w2
    s_cmp_ge_i32 s53, 3
    s_cbranch_scc1 LA_w1
    s_waitcnt vmcnt(0)
    s_branch LA_bar
LA_w1:
    s_waitcnt vmcnt(8)
    s_branch LA_bar
LA_w2:
    s_waitcnt vmcnt(16)
LA_bar:
    s_barrier
LA_iss0:
    s_add_i32 s43, s52, 4
    s_sub_u32 s42, s36, 1
    s_min_i32 s43, s43, s42
LA_iss:
    s_cmp_gt_i32 s50, s43
    s_cbranch_scc1 LA_skip
    s_add_u32 s58, s51, s56
    s_cmp_ge_u32 s50, 18
    s_cbranch_scc1 LA_g2
    s_sub_u32 s62, s50, 9
    s_cmp_ge_u32 s50, 9
    s_cselect_b32 s62, s62, s50
    s_lshl_b32 s57, s62, 7
    s_add_u32 s57, s57, s55
    s_add_u32 m0, s58, 0
    s_add_u32 s54, s57, 0
    buffer_load_dwordx4 v1, s[72:75], s54 offen sc1 lds
    s_add_u32 m0, s58, 1024
    s_add_u32 s54, s57, 9216
    buffer_load_dwordx4 v2, s[72:75], s54 offen sc1 lds
    s_add_u32 m0, s58, 2048
    s_add_u32 s54, s57, 18432
    buffer_load_dwordx4 v1, s[72:75], s54 offen sc1 lds
    s_add_u32 m0, s58, 3072
    s_add_u32 s54, s57, 27648
    buffer_load_dwordx4 v2, s[72:75], s54 offen sc1 lds
    s_add_u32 m0, s58, 4096
    s_add_u32 s54, s57, 36864
    buffer_load_dwordx4 v1, s[72:75], s54 offen sc1 lds
    s_add_u32 m0, s58, 5120
    s_add_u32 s54, s57, 46080
    buffer_load_dwordx4 v2, s[72:75], s54 offen sc1 lds
    s_add_u32 m0, s58, 6144
    s_add_u32 s54, s57, 55296
    buffer_load_dwordx4 v1, s[72:75], s54 offen sc1 lds
    s_add_u32 m0, s58, 7168
    s_add_u32 s54, s57, 64512
    buffer_load_dwordx4 v2, s[72:75], s54 offen sc1 lds
    s_branch LA_end
LA_g2:
    s_sub_u32 s62, s50, 18
    s_cmp_lg_u32 s62, s66
    s_cbranch_scc1 LA_np
    v_and_b32 v63, 31, v0
    v_lshlrev_b32 v63, 3, v63
    s_mov_b32 s101, 0
poll_37:
    s_add_u32 s101, s101, 1
    s_cmp_ge_u32 s101, 0x40000
    s_cbranch_scc1 polld_38
    buffer_load_dwordx2 v[60:61], v63, s[92:95], s47 offen sc1
    s_waitcnt vmcnt(0)
    v_cmp_eq_u32 s[62:63], s14, v60
    v_cmp_eq_u32 vcc, s15, v61
    s_nop 1
    s_and_b32 s40, s62, vcc_lo
    s_and_b32 s40, s40, s48
    s_cmp_eq_u32 s40, s48
    s_cbranch_scc1 polld_38
    s_sleep 4
    s_branch poll_37
polld_38:
LA_np:
    s_sub_u32 s62, s50, 18
    s_cmp_lg_u32 s62, s89
    s_cbranch_scc1 LA_np2
    v_and_b32 v63, 31, v0
    v_lshlrev_b32 v63, 3, v63
    s_mov_b32 s101, 0
poll_39:
    s_add_u32 s101, s101, 1
    s_cmp_ge_u32 s101, 0x40000
    s_cbranch_scc1 polld_40
    buffer_load_dwordx2 v[60:61], v63, s[92:95], s47 offen sc1
    s_waitcnt vmcnt(0)
    v_cmp_eq_u32 s[62:63], s14, v60
    v_cmp_eq_u32 vcc, s15, v61
    s_nop 1
    s_and_b32 s40, s62, vcc_lo
    s_and_b32 s40, s40, s46
    s_cmp_eq_u32 s40, s46
    s_cbranch_scc1 polld_40
    s_sleep 4
    s_branch poll_39
polld_40:
LA_np2:
    s_sub_u32 s62, s50, 18
    s_mul_i32 s63, s26, 13
    s_cmp_lt_u32 s62, s66
    s_cbranch_scc1 1f
    s_cmp_lt_u32 s62, s89
    s_cbranch_scc1 2f
    s_sub_u32 s62, s62, s89
    s_mul_i32 s63, s26, 9
    s_add_u32 s63, s63, 91
    s_branch 1f
2:
    s_sub_u32 s62, s62, s66
    s_mul_i32 s63, s26, 5
    s_add_u32 s63, s63, 64
    s_cmp_eq_u32 s26, 4
    s_addc_u32 s63, s63, 0
1:
    s_add_u32 s62, s62, s63
    s_lshr_b32 s63, s62, 5
    s_sub_u32 s41, s63, 2
    s_lshl_b32 s41, s41, 23
    s_add_u32 s68, s60, s41
    s_addc_u32 s69, s61, 0
    s_cmp_eq_u32 s63, 0
    s_cselect_b32 s68, s6, s68
    s_cselect_b32 s69, s7, s69
    s_cmp_eq_u32 s63, 1
    s_cselect_b32 s68, s8, s68
    s_cselect_b32 s69, s9, s69
    s_and_b32 s69, s69, 0xffff
    s_and_b32 s57, s62, 31
    s_lshl_b32 s57, s57, 7
    s_add_u32 s57, s57, s49
    s_add_u32 m0, s58, 0
    s_add_u32 s54, s57, 0
    buffer_load_dwordx4 v3, s[68:71], s54 offen sc1 lds
    s_add_u32 m0, s58, 1024
    s_add_u32 s54, s57, 32768
    buffer_load_dwordx4 v4, s[68:71], s54 offen sc1 lds
    s_add_u32 m0, s58, 2048
    s_add_u32 s54, s57, 65536
    buffer_load_dwordx4 v3, s[68:71], s54 offen sc1 lds
    s_add_u32 m0, s58, 3072
    s_add_u32 s54, s57, 98304
    buffer_load_dwordx4 v4, s[68:71], s54 offen sc1 lds
    s_add_u32 m0, s58, 4096
    s_add_u32 s54, s57, 131072
    buffer_load_dwordx4 v3, s[68:71], s54 offen sc1 lds
    s_add_u32 m0, s58, 5120
    s_add_u32 s54, s57, 163840
    buffer_load_dwordx4 v4, s[68:71], s54 offen sc1 lds
    s_add_u32 m0, s58, 6144
    s_add_u32 s54, s57, 196608
    buffer_load_dwordx4 v3, s[68:71], s54 offen sc1 lds
    s_add_u32 m0, s58, 7168
    s_add_u32 s54, s57, 229376
    buffer_load_dwordx4 v4, s[68:71], s54 offen sc1 lds
LA_end:
    s_add_u32 s50, s50, 1
    s_add_u32 s51, s51, 16384
    s_cmp_ge_u32 s51, 65536
    s_cselect_b32 s51, 0, s51
    s_branch LA_iss
LA_skip:
    s_add_i32 s52, s52, 1
    s_cmp_lt_i32 s52, s36
    s_cbranch_scc1 LA_loop
    s_endpgm
K_loadB:
    s_sub_u32 s59, s3, 10
    s_cmp_ge_u32 s65, 3
    s_cselect_b32 s60, s12, s10
    s_cselect_b32 s61, s13, s11
    s_mov_b32 s72, s60
    s_and_b32 s73, s61, 0xffff
    s_mov_b32 s74, 663552
    s_mov_b32 s75, 0x00020000
    s_mov_b32 s76, s16
    s_and_b32 s77, s17, 0xffff
    s_mov_b32 s78, 5308416
    s_mov_b32 s79, 0x00020000
    v_and_b32 v60, 63, v0
    v_lshrrev_b32 v61, 3, v60
    v_mul_u32_u24 v61, 1152, v61
    v_and_b32 v62, 7, v60
    v_lshrrev_b32 v63, 4, v60
    v_xor_b32 v62, v62, v63
    v_lshl_add_u32 v1, v62, 4, v61
    v_xor_b32 v62, 4, v62
    v_lshl_add_u32 v2, v62, 4, v61
    v_and_b32 v60, 63, v0
    v_add_u32 v61, 0, v60
    v_mul_u32_u24 v62, 2731, v61
    v_lshrrev_b32 v62, 16, v62
    v_mul_u32_u24 v63, 24, v62
    v_sub_u32 v61, v61, v63
    v_and_b32 v63, 2, v62
    v_lshlrev_b32 v63, 1, v63
    v_xor_b32 v61, v61, v63
    v_lshrrev_b32 v63, 2, v62
    v_and_b32 v63, 2, v63
    v_xor_b32 v61, v61, v63
    v_mul_u32_u24 v62, 9216, v62
    v_lshl_add_u32 v3, v61, 4, v62
    v_add_u32 v61, 64, v60
    v_mul_u32_u24 v62, 2731, v61
    v_lshrrev_b32 v62, 16, v62
    v_mul_u32_u24 v63, 24, v62
    v_sub_u32 v61, v61, v63
    v_and_b32 v63, 2, v62
    v_lshlrev_b32 v63, 1, v63
    v_xor_b32 v61, v61, v63
    v_lshrrev_b32 v63, 2, v62
    v_and_b32 v63, 2, v63
    v_xor_b32 v61, v61, v63
    v_mul_u32_u24 v62, 9216, v62
    v_lshl_add_u32 v4, v61, 4, v62
    v_add_u32 v61, 128, v60
    v_mul_u32_u24 v62, 2731, v61
    v_lshrrev_b32 v62, 16, v62
    v_mul_u32_u24 v63, 24, v62
    v_sub_u32 v61, v61, v63
    v_and_b32 v63, 2, v62
    v_lshlrev_b32 v63, 1, v63
    v_xor_b32 v61, v61, v63
    v_lshrrev_b32 v63, 2, v62
    v_and_b32 v63, 2, v63
    v_xor_b32 v61, v61, v63
    v_mul_u32_u24 v62, 9216, v62
    v_lshl_add_u32 v5, v61, 4, v62
    v_add_u32 v61, 192, v60
    v_mul_u32_u24 v62, 2731, v61
    v_lshrrev_b32 v62, 16, v62
    v_mul_u32_u24 v63, 24, v62
    v_sub_u32 v61, v61, v63
    v_and_b32 v63, 2, v62
    v_lshlrev_b32 v63, 1, v63
    v_xor_b32 v61, v61, v63
    v_lshrrev_b32 v63, 2, v62
    v_and_b32 v63, 2, v63
    v_xor_b32 v61, v61, v63
    v_mul_u32_u24 v62, 9216, v62
    v_lshl_add_u32 v6, v61, 4, v62
    v_add_u32 v61, 256, v60
    v_mul_u32_u24 v62, 2731, v61
    v_lshrrev_b32 v62, 16, v62
    v_mul_u32_u24 v63, 24, v62
    v_sub_u32 v61, v61, v63
    v_and_b32 v63, 2, v62
    v_lshlrev_b32 v63, 1, v63
    v_xor_b32 v61, v61, v63
    v_lshrrev_b32 v63, 2, v62
    v_and_b32 v63, 2, v63
    v_xor_b32 v61, v61, v63
    v_mul_u32_u24 v62, 9216, v62
    v_lshl_add_u32 v7, v61, 4, v62
    v_add_u32 v61, 320, v60
    v_mul_u32_u24 v62, 2731, v61
    v_lshrrev_b32 v62, 16, v62
    v_mul_u32_u24 v63, 24, v62
    v_sub_u32 v61, v61, v63
    v_and_b32 v63, 2, v62
    v_lshlrev_b32 v63, 1, v63
    v_xor_b32 v61, v61, v63
    v_lshrrev_b32 v63, 2, v62
    v_and_b32 v63, 2, v63
    v_xor_b32 v61, v61, v63
    v_mul_u32_u24 v62, 9216, v62
    v_lshl_add_u32 v8, v61, 4, v62
    v_and_b32 v60, 63, v0
    v_add_u32 v61, 0, v60
    v_mul_u32_u24 v62, 2731, v61
    v_lshrrev_b32 v62, 16, v62
    v_mul_u32_u24 v63, 24, v62
    v_sub_u32 v61, v61, v63
    v_and_b32 v63, 2, v62
    v_lshlrev_b32 v63, 1, v63
    v_xor_b32 v61, v61, v63
    v_lshrrev_b32 v63, 2, v62
    v_and_b32 v63, 2, v63
    v_xor_b32 v61, v61, v63
    v_mul_u32_u24 v62, 1152, v62
    v_lshl_add_u32 v9, v61, 4, v62
    v_add_u32 v61, 64, v60
    v_mul_u32_u24 v62, 2731, v61
    v_lshrrev_b32 v62, 16, v62
    v_mul_u32_u24 v63, 24, v62
    v_sub_u32 v61, v61, v63
    v_and_b32 v63, 2, v62
    v_lshlrev_b32 v63, 1, v63
    v_xor_b32 v61, v61, v63
    v_lshrrev_b32 v63, 2, v62
    v_and_b32 v63, 2, v63
    v_xor_b32 v61, v61, v63
    v_mul_u32_u24 v62, 1152, v62
    v_lshl_add_u32 v10, v61, 4, v62
    v_add_u32 v61, 128, v60
    v_mul_u32_u24 v62, 2731, v61
    v_lshrrev_b32 v62, 16, v62
    v_mul_u32_u24 v63, 24, v62
    v_sub_u32 v61, v61, v63
    v_and_b32 v63, 2, v62
    v_lshlrev_b32 v63, 1, v63
    v_xor_b32 v61, v61, v63
    v_lshrrev_b32 v63, 2, v62
    v_and_b32 v63, 2, v63
    v_xor_b32 v61, v61, v63
    v_mul_u32_u24 v62, 1152, v62
    v_lshl_add_u32 v11, v61, 4, v62
    v_add_u32 v61, 192, v60
    v_mul_u32_u24 v62, 2731, v61
    v_lshrrev_b32 v62, 16, v62
    v_mul_u32_u24 v63, 24, v62
    v_sub_u32 v61, v61, v63
    v_and_b32 v63, 2, v62
    v_lshlrev_b32 v63, 1, v63
    v_xor_b32 v61, v61, v63
    v_lshrrev_b32 v63, 2, v62
    v_and_b32 v63, 2, v63
    v_xor_b32 v61, v61, v63
    v_mul_u32_u24 v62, 1152, v62
    v_lshl_add_u32 v12, v61, 4, v62
    v_add_u32 v61, 256, v60
    v_mul_u32_u24 v62, 2731, v61
    v_lshrrev_b32 v62, 16, v62
    v_mul_u32_u24 v63, 24, v62
    v_sub_u32 v61, v61, v63
    v_and_b32 v63, 2, v62
    v_lshlrev_b32 v63, 1, v63
    v_xor_b32 v61, v61, v63
    v_lshrrev_b32 v63, 2, v62
    v_and_b32 v63, 2, v63
    v_xor_b32 v61, v61, v63
    v_mul_u32_u24 v62, 1152, v62
    v_lshl_add_u32 v13, v61, 4, v62
    v_add_u32 v61, 320, v60
    v_mul_u32_u24 v62, 2731, v61
    v_lshrrev_b32 v62, 16, v62
    v_mul_u32_u24 v63, 24, v62
    v_sub_u32 v61, v61, v63
    v_and_b32 v63, 2, v62
    v_lshlrev_b32 v63, 1, v63
    v_xor_b32 v61, v61, v63
    v_lshrrev_b32 v63, 2, v62
    v_and_b32 v63, 2, v63
    v_xor_b32 v61, v61, v63
    v_mul_u32_u24 v62, 1152, v62
    v_lshl_add_u32 v14, v61, 4, v62
    s_mul_i32 s56, s59, 294912
    s_add_u32 s41, s65, 9
    s_mul_i32 s49, s41, 384
    s_add_u32 s49, s49, s56
    s_sub_u32 s41, s65, 6
    s_mul_i32 s55, s41, 384
    s_add_u32 s55, s55, s56
    s_cmp_ge_u32 s65, 6
    s_cbranch_scc1 LB_s1
    s_cmp_ge_u32 s65, 3
    s_cselect_b32 s41, 3, 0
    s_sub_u32 s41, s65, s41
    s_mul_i32 s41, s41, 192
    s_mul_i32 s56, s59, 96
    s_add_u32 s41, s41, s56
    s_mul_i32 s55, s41, 1152
LB_s1:
    s_mul_i32 s48, s39, 384
    s_mul_i32 s56, s59, 36864
    s_add_u32 s48, s48, s56
    s_mul_i32 s56, s59, 12288
    s_add_u32 s60, s24, 4194304
    s_addc_u32 s61, s25, 0
    s_mov_b32 s71, 0x00020000
    s_mov_b32 s50, 0
    s_mov_b32 s51, 65536
    s_mov_b32 s52, -4
LB_loop:
    s_cmp_lt_i32 s52, -1
    s_cbranch_scc1 LB_iss0
    s_cmp_lg_i32 s52, -1
    s_cbranch_scc1 LB_nx
    s_barrier
LB_nx:
    s_sub_i32 s53, s50, s52
    s_cmp_ge_i32 s53, 4
    s_cbranch_scc1 LB_w2
    s_cmp_ge_i32 s53, 3
    s_cbranch_scc1 LB_w1
    s_waitcnt vmcnt(0)
    s_branch LB_bar
LB_w1:
    s_waitcnt vmcnt(12)
    s_branch LB_bar
LB_w2:
    s_waitcnt vmcnt(24)
LB_bar:
    s_barrier
LB_iss0:
    s_add_i32 s43, s52, 4
    s_cmp_ge_i32 s52, 14
    s_cselect_b32 s42, 17, s43
    s_cmp_le_i32 s52, 15
    s_cselect_b32 s43, s42, s43
    s_sub_u32 s42, s36, 1
    s_min_i32 s43, s43, s42
LB_iss:
    s_cmp_gt_i32 s50, s43
    s_cbranch_scc1 LB_skip
    s_add_u32 s58, s51, s56
    s_cmp_ge_u32 s50, 18
    s_cbranch_scc1 LB_g2
    s_cmp_ge_u32 s50, 9
    s_cbranch_scc1 LB_t2
    s_cmp_ge_u32 s65, 6
    s_cbranch_scc1 LB_t1kn
    s_lshl_b32 s57, s50, 7
    s_add_u32 s57, s57, s55
    s_add_u32 m0, s58, 0
    s_add_u32 s54, s57, 0
    buffer_load_dwordx4 v1, s[72:75], s54 offen  lds
    s_add_u32 m0, s58, 1024
    s_add_u32 s54, s57, 9216
    buffer_load_dwordx4 v2, s[72:75], s54 offen  lds
    s_add_u32 m0, s58, 2048
    s_add_u32 s54, s57, 18432
    buffer_load_dwordx4 v1, s[72:75], s54 offen  lds
    s_add_u32 m0, s58, 3072
    s_add_u32 s54, s57, 27648
    buffer_load_dwordx4 v2, s[72:75], s54 offen  lds
    s_add_u32 m0, s58, 4096
    s_add_u32 s54, s57, 36864
    buffer_load_dwordx4 v1, s[72:75], s54 offen  lds
    s_add_u32 m0, s58, 5120
    s_add_u32 s54, s57, 46080
    buffer_load_dwordx4 v2, s[72:75], s54 offen  lds
    s_add_u32 m0, s58, 6144
    s_add_u32 s54, s57, 55296
    buffer_load_dwordx4 v1, s[72:75], s54 offen  lds
    s_add_u32 m0, s58, 7168
    s_add_u32 s54, s57, 64512
    buffer_load_dwordx4 v2, s[72:75], s54 offen  lds
    s_add_u32 m0, s58, 8192
    s_add_u32 s54, s57, 73728
    buffer_load_dwordx4 v1, s[72:75], s54 offen  lds
    s_add_u32 m0, s58, 9216
    s_add_u32 s54, s57, 82944
    buffer_load_dwordx4 v2, s[72:75], s54 offen  lds
    s_add_u32 m0, s58, 10240
    s_add_u32 s54, s57, 92160
    buffer_load_dwordx4 v1, s[72:75], s54 offen  lds
    s_add_u32 m0, s58, 11264
    s_add_u32 s54, s57, 101376
    buffer_load_dwordx4 v2, s[72:75], s54 offen  lds
    s_branch LB_end
LB_t1kn:
    s_mul_i32 s57, s50, 589824
    s_add_u32 s57, s57, s55
    s_branch LB_kn
LB_t2:
    s_sub_u32 s62, s50, 9
    s_mul_i32 s57, s62, 589824
    s_add_u32 s57, s57, s49
LB_kn:
    s_add_u32 m0, s58, 0
    s_add_u32 s54, s57, 0
    buffer_load_dwordx4 v3, s[76:79], s54 offen  lds
    s_add_u32 m0, s58, 1024
    s_add_u32 s54, s57, 0
    buffer_load_dwordx4 v4, s[76:79], s54 offen  lds
    s_add_u32 m0, s58, 2048
    s_add_u32 s54, s57, 0
    buffer_load_dwordx4 v5, s[76:79], s54 offen  lds
    s_add_u32 m0, s58, 3072
    s_add_u32 s54, s57, 0
    buffer_load_dwordx4 v6, s[76:79], s54 offen  lds
    s_add_u32 m0, s58, 4096
    s_add_u32 s54, s57, 0
    buffer_load_dwordx4 v7, s[76:79], s54 offen  lds
    s_add_u32 m0, s58, 5120
    s_add_u32 s54, s57, 0
    buffer_load_dwordx4 v8, s[76:79], s54 offen  lds
    s_add_u32 m0, s58, 6144
    s_add_u32 s54, s57, 147456
    buffer_load_dwordx4 v3, s[76:79], s54 offen  lds
    s_add_u32 m0, s58, 7168
    s_add_u32 s54, s57, 147456
    buffer_load_dwordx4 v4, s[76:79], s54 offen  lds
    s_add_u32 m0, s58, 8192
    s_add_u32 s54, s57, 147456
    buffer_load_dwordx4 v5, s[76:79], s54 offen  lds
    s_add_u32 m0, s58, 9216
    s_add_u32 s54, s57, 147456
    buffer_load_dwordx4 v6, s[76:79], s54 offen  lds
    s_add_u32 m0, s58, 10240
    s_add_u32 s54, s57, 147456
    buffer_load_dwordx4 v7, s[76:79], s54 offen  lds
    s_add_u32 m0, s58, 11264
    s_add_u32 s54, s57, 147456
    buffer_load_dwordx4 v8, s[76:79], s54 offen  lds
    s_branch LB_end
LB_g2:
    s_cmp_lg_u32 s50, 18
    s_cbranch_scc1 LB_n0
    v_mov_b32 v63, 0
    s_mov_b32 s101, 0
nonce_41:
    s_add_u32 s101, s101, 1
    s_cmp_ge_u32 s101, 0x40000
    s_cbranch_scc1 nonced_42
    buffer_load_dwordx2 v[60:61], v63, s[28:31], 0 offen sc1
    s_waitcnt vmcnt(0)
    v_readfirstlane_b32 s14, v60
    v_readfirstlane_b32 s15, v61
    s_or_b32 s40, s14, s15
    s_cmp_lg_u32 s40, 0
    s_cbranch_scc1 nonced_42
    s_sleep 2
    s_branch nonce_41
nonced_42:
    s_mov_b32 s47, 0
LB_n0:
    s_sub_u32 s62, s50, 18
    s_mul_i32 s63, s26, 13
    s_cmp_lt_u32 s62, s66
    s_cbranch_scc1 1f
    s_cmp_lt_u32 s62, s89
    s_cbranch_scc1 2f
    s_sub_u32 s62, s62, s89
    s_mul_i32 s63, s26, 9
    s_add_u32 s63, s63, 91
    s_branch 1f
2:
    s_sub_u32 s62, s62, s66
    s_mul_i32 s63, s26, 5
    s_add_u32 s63, s63, 64
    s_cmp_eq_u32 s26, 4
    s_addc_u32 s63, s63, 0
1:
    s_add_u32 s62, s62, s63
    s_cmp_ge_u32 s62, 64
    s_cbranch_scc1 LB_np
    s_lshr_b32 s46, s62, 1
    s_bitcmp1_b32 s47, s46
    s_cbranch_scc1 LB_np
    s_mov_b32 s42, s62
    s_lshl_b32 s41, s39, 8
    s_add_u32 s41, s41, 2048
    v_and_b32 v63, 31, v0
    v_lshlrev_b32 v63, 3, v63
    s_mov_b32 s101, 0
LB_pl:
    s_add_u32 s101, s101, 1
    s_cmp_ge_u32 s101, 0x40000
    s_cbranch_scc1 LB_pd
    buffer_load_dwordx2 v[60:61], v63, s[92:95], s41 offen sc1
    s_waitcnt vmcnt(0)
    v_cmp_eq_u32 s[62:63], s14, v60
    v_cmp_eq_u32 vcc, s15, v61
    s_nop 1
    s_and_b32 s47, s62, vcc_lo
    s_bitcmp1_b32 s47, s46
    s_cbranch_scc1 LB_pd
    s_sleep 2
    s_branch LB_pl
LB_pd:
    s_mov_b32 s62, s42
LB_np:
    s_sub_u32 s63, s62, 64
    s_cmp_lt_u32 s62, 64
    s_cselect_b32 s63, s62, s63
    s_cselect_b32 s68, s60, s18
    s_cselect_b32 s69, s61, s19
    s_mov_b32 s70, 5308416
    s_cselect_b32 s70, 4718592, s70
    s_and_b32 s69, s69, 0xffff
    s_mul_i32 s57, s63, 73728
    s_add_u32 s57, s57, s48
    s_add_u32 m0, s58, 0
    s_add_u32 s54, s57, 0
    buffer_load_dwordx4 v9, s[68:71], s54 offen sc1 lds
    s_add_u32 m0, s58, 1024
    s_add_u32 s54, s57, 0
    buffer_load_dwordx4 v10, s[68:71], s54 offen sc1 lds
    s_add_u32 m0, s58, 2048
    s_add_u32 s54, s57, 0
    buffer_load_dwordx4 v11, s[68:71], s54 offen sc1 lds
    s_add_u32 m0, s58, 3072
    s_add_u32 s54, s57, 0
    buffer_load_dwordx4 v12, s[68:71], s54 offen sc1 lds
    s_add_u32 m0, s58, 4096
    s_add_u32 s54, s57, 0
    buffer_load_dwordx4 v13, s[68:71], s54 offen sc1 lds
    s_add_u32 m0, s58, 5120
    s_add_u32 s54, s57, 0
    buffer_load_dwordx4 v14, s[68:71], s54 offen sc1 lds
    s_add_u32 m0, s58, 6144
    s_add_u32 s54, s57, 18432
    buffer_load_dwordx4 v9, s[68:71], s54 offen sc1 lds
    s_add_u32 m0, s58, 7168
    s_add_u32 s54, s57, 18432
    buffer_load_dwordx4 v10, s[68:71], s54 offen sc1 lds
    s_add_u32 m0, s58, 8192
    s_add_u32 s54, s57, 18432
    buffer_load_dwordx4 v11, s[68:71], s54 offen sc1 lds
    s_add_u32 m0, s58, 9216
    s_add_u32 s54, s57, 18432
    buffer_load_dwordx4 v12, s[68:71], s54 offen sc1 lds
    s_add_u32 m0, s58, 10240
    s_add_u32 s54, s57, 18432
    buffer_load_dwordx4 v13, s[68:71], s54 offen sc1 lds
    s_add_u32 m0, s58, 11264
    s_add_u32 s54, s57, 18432
    buffer_load_dwordx4 v14, s[68:71], s54 offen sc1 lds
LB_end:
    s_add_u32 s50, s50, 1
    s_add_u32 s51, s51, 24576
    s_cmp_ge_u32 s51, 163840
    s_cselect_b32 s51, 65536, s51
    s_branch LB_iss
LB_skip:
    s_add_i32 s52, s52, 1
    s_cmp_lt_i32 s52, s36
    s_cbranch_scc1 LB_loop
    s_endpgm
K_done:
    s_endpgm
.section .rodata,"a"
.p2align 6
.amdhsa_kernel parallel_sum__spectral_fnet__dense_activation_relu__prompt_kernel
  .amdhsa_next_free_vgpr 168
  .amdhsa_next_free_sgpr 102
  .amdhsa_accum_offset 168
  .amdhsa_group_segment_fixed_size 0
  .amdhsa_kernarg_size 88
  .amdhsa_user_sgpr_count 2
  .amdhsa_user_sgpr_kernarg_segment_ptr 1
  .amdhsa_system_sgpr_workgroup_id_x 1
  .amdhsa_float_denorm_mode_32 3
  .amdhsa_float_denorm_mode_16_64 3
.end_amdhsa_kernel
```
